```python
import torch

def _softmax(x, axis=-1):
    return torch.softmax(x, dim=axis)
def _gelu(x):
    return torch.nn.functional.gelu(x, approximate="tanh")
def _silu(x):
    return torch.nn.functional.silu(x)
def _sigmoid(x):
    return torch.sigmoid(x)
def _layernorm(x, axis=-1, eps=1e-5):
    m = x.mean(dim=axis, keepdim=True)
    v = x.var(dim=axis, keepdim=True, unbiased=False)
    return (x - m) / torch.sqrt(v + eps)
def _scatter_add(tgt, idx, src, axis=0):
    return tgt.clone().index_add_(axis, idx, src)
def _segment_sum(src, seg, n):
    out = torch.zeros((n,) + src.shape[1:], dtype=src.dtype)
    return out.index_add_(0, seg, src)
def _pad(x, pw):
    flat = tuple(v for pair in reversed(pw) for v in pair)
    return torch.nn.functional.pad(x, flat)

kernel_name = 'standalone__gqa_block_cached__decode'

def setup_inputs():

    _w = (lambda a: (lambda t: t.to(torch.bfloat16) if t.is_floating_point() else t)(torch.as_tensor(a)))
    B, Sq, D = 4, 1, 576
    Hq, Hkv, Sk, Dh = 32, 16, 8192, 128
    assert Hq % Hkv == 0, (Hq, Hkv)
    return {
        "x": _w((lambda *s: torch.randn(*s, dtype=torch.bfloat16) * 0.8)(B, Sq, D)),
        "k_cache": _w((lambda *s: torch.randn(*s, dtype=torch.bfloat16) * 0.8)(B, Hkv, Sk, Dh)),
        "v_cache": _w((lambda *s: torch.randn(*s, dtype=torch.bfloat16) * 0.05)(B, Hkv, Sk, Dh)),
        "wq": _w((lambda *s: torch.randn(*s, dtype=torch.bfloat16) * 0.8)(D, Hq * Dh) * (D ** -0.5)),
        "wo": _w((lambda *s: torch.randn(*s, dtype=torch.bfloat16) * 0.05)(Hq * Dh, D) * ((Hq * Dh) ** -0.5)),
    }

def reference(x, k_cache, v_cache, wq, wo):
    B, Sq, D = x.shape
    Hq, Dh = 32, 128
    Hkv = k_cache.shape[1]
    rep = Hq // Hkv
    q = (lambda x, *d: x.permute(*d))((x @ wq).reshape(B, Sq, Hq, Dh), 0, 2, 1, 3)
    k = (lambda x, n, axis: torch.repeat_interleave(x, n, dim=axis))(k_cache, rep, axis=1)
    v = (lambda x, n, axis: torch.repeat_interleave(x, n, dim=axis))(v_cache, rep, axis=1)
    scores = torch.einsum("bhqd,bhkd->bhqk", q, k) * (Dh ** -0.5)
    p = _softmax(scores, axis=-1)
    o = torch.einsum("bhqk,bhkd->bhqd", p, v)
    return (lambda x, *d: x.permute(*d))(o, 0, 2, 1, 3).reshape(B, Sq, Hq * Dh) @ wo
```

```asm
; @launch grid=(256,1,1) block=(320,1,1) lds=40064
.amdgcn_target "amdgcn-amd-amdhsa--gfx950"
.text
.globl standalone__gqa_block_cached__decode_kernel
.p2align 9
.fill 64, 4, 0xbf810000
.p2align 8
.type standalone__gqa_block_cached__decode_kernel,@function
standalone__gqa_block_cached__decode_kernel:
  s_cmpk_ge_u32 s2, 256
  s_cbranch_scc1 L_end
  s_load_dwordx16 s[4:19], s[0:1], 0
  v_lshrrev_b32 v3, 6, v0
  v_and_b32 v0, 63, v0
  v_readfirstlane_b32 s3, v3
  s_mov_b32 s24, s2
  s_and_b32 s44, s2, 7
  s_bfe_u32 s45, s2, 0x30003
  s_andn2_b32 s2, s2, 63
  s_lshl3_add_u32 s2, s44, s2
  s_add_u32 s2, s2, s45
  v_lshrrev_b32 v9, 4, v0
  v_and_b32 v8, 3, v0
  s_cmp_lg_u32 s3, 0
  s_cbranch_scc1 L_attn
  s_and_b32 s44, s2, 63
  s_lshr_b32 s47, s2, 6
  s_mul_i32 s45, s47, 9216
  s_add_u32 s45, s45, s44
  s_lshl_b32 s45, s45, 7
  s_mul_i32 s56, s47, 288
  v_lshlrev_b32 v2, 4, v0
  v_lshrrev_b32 v4, 3, v0
  v_and_b32 v5, 6, v4
  v_xor_b32 v5, v5, v0
  v_and_b32 v5, 7, v5
  v_lshlrev_b32 v5, 4, v5
  v_lshl_add_u32 v6, v4, 13, v5
  s_mov_b32 s34, 4718592
  s_mov_b32 s35, 0x20000
  s_movk_i32 s38, 4608
  s_mov_b32 s39, s35
  s_movk_i32 m0, 19584
  v_mov_b32 v3, 18944
  v_mov_b32 v12, 0
  v_mov_b32 v13, 0
  ds_write2_b64 v3, v[12:13], v[12:13] offset0:0 offset1:1
  ds_write2_b64 v3, v[12:13], v[12:13] offset0:2 offset1:3
  s_mov_b64 exec, 0x3ffff
  s_waitcnt lgkmcnt(0)
  s_mov_b64 s[36:37], s[4:5]
  s_mov_b64 s[32:33], s[10:11]
  buffer_load_dwordx4 v2, s[36:39], s56 offen offset:0 lds
  buffer_load_dwordx4 v2, s[36:39], s56 offen offset:1152 lds
  buffer_load_dwordx4 v2, s[36:39], s56 offen offset:2304 lds
  buffer_load_dwordx4 v2, s[36:39], s56 offen offset:3456 lds
  s_mov_b32 m0, 0
  s_mov_b64 exec, -1
L_wq:
  buffer_load_dwordx4 v6, s[32:35], s45 offen nt lds
  s_addk_i32 m0, 1024
  s_add_u32 s45, s45, 0x10000
  s_cmpk_lt_u32 m0, 18432
  s_cbranch_scc1 L_wq
  s_barrier
  s_branch L_help
L_attn:
  s_memrealtime s[62:63]
  s_sub_u32 s3, s3, 1
  v_bfe_u32 v3, v0, 2, 1
  v_lshlrev_b32 v1, 8, v3
  v_bfe_u32 v3, v0, 3, 1
  v_lshl_add_u32 v1, v3, 12, v1
  v_lshl_add_u32 v1, v9, 6, v1
  v_lshl_add_u32 v1, v8, 4, v1
  s_andn2_b32 s44, s2, 3
  s_lshl_b32 s44, s44, 19
  s_and_b32 s45, s2, 3
  s_lshl2_add_u32 s45, s45, s3
  s_and_b32 s46, s45, 1
  s_lshl_b32 s45, s45, 1
  s_sub_u32 s45, s45, s46
  s_lshl_b32 s59, s45, 11
  s_mov_b32 s22, 2097152
  s_mov_b32 s23, 0x20000
  s_waitcnt lgkmcnt(0)
  s_add_u32 s20, s6, s44
  s_addc_u32 s21, s7, 0
  buffer_load_dwordx4 v[40:43], v1, s[20:23], s59 offen offset:0 nt
  buffer_load_dwordx4 v[44:47], v1, s[20:23], s59 offen offset:512 nt
  s_barrier
  buffer_load_dwordx4 v[48:51], v1, s[20:23], s59 offen offset:1024 nt
  buffer_load_dwordx4 v[52:55], v1, s[20:23], s59 offen offset:1536 nt
  s_add_u32 s59, s59, 65536
  buffer_load_dwordx4 v[56:59], v1, s[20:23], s59 offen offset:0 nt
  buffer_load_dwordx4 v[60:63], v1, s[20:23], s59 offen offset:512 nt
  s_mov_b64 s[28:29], s[18:19]
  s_mov_b32 s30, 33554432
  s_mov_b32 s31, 0x20000
  s_mov_b32 s41, 0x3e0293ee
  s_add_u32 s34, s8, s44
  s_addc_u32 s35, s9, 0
  s_add_u32 s42, s62, 534
  s_movk_i32 s52, 25
  s_movk_i32 s53, 60
  s_mov_b32 s57, 1
  s_mov_b32 s38, 7
  v_bfe_u32 v3, v0, 3, 1
  v_lshlrev_b32 v18, 8, v3
  v_lshl_add_u32 v18, v9, 6, v18
  v_lshl_add_u32 v18, v8, 4, v18
  v_add_u32 v18, 18432, v18
  v_mov_b32 v19, 18944
  s_lshl_b32 s44, s3, 12
  s_add_u32 s44, s44, 23680
  v_lshrrev_b32 v3, 3, v0
  v_lshl_add_u32 v2, v3, 4, s44
  v_and_b32 v3, 1, v0
  v_mov_b32 v17, 0xffff
  v_lshlrev_b32 v3, 4, v3
  v_lshlrev_b32 v17, v3, v17
  v_bfe_u32 v3, v0, 1, 2
  v_cmp_eq_u32 vcc, 0, v3
  v_mov_b32 v12, 0
  s_nop 0
  v_cndmask_b32 v8, 0, v17, vcc
  v_cmp_eq_u32 vcc, 1, v3
  v_mov_b32 v13, 0
  s_nop 0
  v_cndmask_b32 v9, 0, v17, vcc
  v_cmp_eq_u32 vcc, 2, v3
  v_mov_b32 v14, 0
  s_nop 0
  v_cndmask_b32 v10, 0, v17, vcc
  v_cmp_eq_u32 vcc, 3, v3
  v_mov_b32 v15, 0
  s_nop 0
  v_cndmask_b32 v11, 0, v17, vcc
  v_mov_b32 v16, 0xff800000
  v_mov_b32 v17, 0
  s_waitcnt vmcnt(5)
  buffer_load_dwordx4 v[64:67], v1, s[20:23], s59 offen offset:1024 nt
  s_waitcnt vmcnt(5)
  buffer_load_dwordx4 v[68:71], v1, s[20:23], s59 offen offset:1536 nt
  s_add_u32 s59, s59, 65536
  s_waitcnt vmcnt(5)
  buffer_load_dwordx4 v[104:107], v1, s[20:23], s59 offen offset:0 nt
  s_waitcnt vmcnt(5)
  buffer_load_dwordx4 v[108:111], v1, s[20:23], s59 offen offset:512 nt
  s_waitcnt vmcnt(5)
  buffer_load_dwordx4 v[112:115], v1, s[20:23], s59 offen offset:1024 nt
  s_waitcnt vmcnt(5)
  buffer_load_dwordx4 v[116:119], v1, s[20:23], s59 offen offset:1536 nt
  s_add_u32 s59, s59, 65536
  s_waitcnt vmcnt(5)
  buffer_load_dwordx4 v[120:123], v1, s[20:23], s59 offen offset:0 nt
  s_waitcnt vmcnt(5)
  buffer_load_dwordx4 v[124:127], v1, s[20:23], s59 offen offset:512 nt
  s_waitcnt vmcnt(5)
  buffer_load_dwordx4 v[128:131], v1, s[20:23], s59 offen offset:1024 nt
  s_waitcnt vmcnt(5)
  buffer_load_dwordx4 v[132:135], v1, s[20:23], s59 offen offset:1536 nt
  s_add_u32 s59, s59, 65536
  s_waitcnt vmcnt(5)
  buffer_load_dwordx4 v[136:139], v1, s[20:23], s59 offen offset:0 nt
  s_waitcnt vmcnt(5)
  buffer_load_dwordx4 v[140:143], v1, s[20:23], s59 offen offset:512 nt
  s_waitcnt vmcnt(5)
  buffer_load_dwordx4 v[144:147], v1, s[20:23], s59 offen offset:1024 nt
  s_waitcnt vmcnt(5)
  buffer_load_dwordx4 v[148:151], v1, s[20:23], s59 offen offset:1536 nt
  s_add_u32 s59, s59, 65536
  s_waitcnt vmcnt(5)
  buffer_load_dwordx4 v[152:155], v1, s[20:23], s59 offen offset:0 nt
  s_waitcnt vmcnt(5)
  buffer_load_dwordx4 v[156:159], v1, s[20:23], s59 offen offset:512 nt
  s_waitcnt vmcnt(5)
  buffer_load_dwordx4 v[160:163], v1, s[20:23], s59 offen offset:1024 nt
  s_waitcnt vmcnt(5)
  buffer_load_dwordx4 v[164:167], v1, s[20:23], s59 offen offset:1536 nt
  s_add_u32 s59, s59, 65536
  s_waitcnt vmcnt(5)
  buffer_load_dwordx4 v[72:75], v1, s[20:23], s59 offen offset:0 nt
  s_waitcnt vmcnt(5)
  buffer_load_dwordx4 v[76:79], v1, s[20:23], s59 offen offset:512 nt
  s_waitcnt vmcnt(5)
  buffer_load_dwordx4 v[80:83], v1, s[20:23], s59 offen offset:1024 nt
  s_waitcnt vmcnt(5)
  buffer_load_dwordx4 v[84:87], v1, s[20:23], s59 offen offset:1536 nt
  s_add_u32 s59, s59, 65536
  s_waitcnt vmcnt(5)
  buffer_load_dwordx4 v[88:91], v1, s[20:23], s59 offen offset:0 nt
  s_waitcnt vmcnt(5)
  buffer_load_dwordx4 v[92:95], v1, s[20:23], s59 offen offset:512 nt
  s_waitcnt vmcnt(5)
  buffer_load_dwordx4 v[96:99], v1, s[20:23], s59 offen offset:1024 nt
  s_waitcnt vmcnt(5)
  buffer_load_dwordx4 v[100:103], v1, s[20:23], s59 offen offset:1536 nt
  s_add_u32 s59, s59, 65536
  s_mov_b32 s61, 0x400000
L_qwait:
  ds_read_b64 v[20:21], v19
  ds_read_b128 v[4:7], v18
  s_waitcnt lgkmcnt(0)
  v_readfirstlane_b32 s39, v20
  v_readfirstlane_b32 s40, v21
  s_cmp_lg_u32 s39, 0
  s_cbranch_scc1 L_qgo
  s_sleep 1
  s_sub_u32 s61, s61, 1
  s_cbranch_scc0 L_qwait
L_qgo:
L_kk:
  s_cmp_lg_u32 s38, 1
  s_cbranch_scc1 L_kk0
  s_mov_b64 s[20:21], s[34:35]
  s_and_b32 s59, s59, 0xffff
  v_and_b32 v3, 31, v0
  v_lshlrev_b32 v1, 4, v3
  v_lshrrev_b32 v3, 5, v0
  v_lshl_add_u32 v1, v3, 12, v1
L_kk0:
  s_mov_b32 s48, s59
  s_add_u32 s49, s59, 65536
  s_add_u32 s59, s59, 131072
  s_waitcnt lgkmcnt(0)
  s_sub_u32 s43, s62, s42
  s_cmp_gt_i32 s43, 0
  s_cselect_b32 s46, 1, 0
  s_cmp_gt_i32 s43, s53
  s_addc_u32 s46, s46, 0
  s_cmp_gt_i32 s43, s52
  s_cselect_b64 vcc, -1, 0
  s_addc_u32 s46, s46, 0
  s_addk_i32 s42, 108
  s_addk_i32 s52, 3
  s_addk_i32 s53, 7
  s_bitcmp1_b32 s46, 0
  s_waitcnt vmcnt(15)
  v_mfma_f32_16x16x32_bf16 v[24:27], v[40:43], v[4:7], 0
  s_waitcnt vmcnt(14)
  v_mfma_f32_16x16x32_bf16 v[28:31], v[44:47], v[4:7], 0
  s_waitcnt vmcnt(13)
  v_mfma_f32_16x16x32_bf16 v[32:35], v[48:51], v[4:7], 0
  s_waitcnt vmcnt(12)
  v_mfma_f32_16x16x32_bf16 v[36:39], v[52:55], v[4:7], 0
  s_waitcnt vmcnt(7)
  s_cbranch_vccz L_wl1
  s_cbranch_scc1 L_wd1
  s_waitcnt vmcnt(6)
  s_branch L_wd1
L_wl1:
  s_waitcnt vmcnt(5)
  s_cbranch_scc1 L_wd1
  s_waitcnt vmcnt(4)
L_wd1:
  buffer_load_dwordx4 v[40:43], v1, s[20:23], s48 offen offset:0 nt
  s_nop 4
  v_mov_b32_dpp v20, v24 quad_perm:[0,0,0,0] row_mask:0xf bank_mask:0xf
  v_mov_b32_dpp v21, v28 quad_perm:[0,0,0,0] row_mask:0xf bank_mask:0xf
  v_mov_b32_dpp v22, v32 quad_perm:[0,0,0,0] row_mask:0xf bank_mask:0xf
  v_mov_b32_dpp v23, v36 quad_perm:[0,0,0,0] row_mask:0xf bank_mask:0xf
  v_add_f32_dpp v20, v25, v20 quad_perm:[1,1,1,1] row_mask:0xf bank_mask:0xf
  v_add_f32_dpp v21, v29, v21 quad_perm:[1,1,1,1] row_mask:0xf bank_mask:0xf
  v_add_f32_dpp v22, v33, v22 quad_perm:[1,1,1,1] row_mask:0xf bank_mask:0xf
  v_add_f32_dpp v23, v37, v23 quad_perm:[1,1,1,1] row_mask:0xf bank_mask:0xf
  v_add_f32_dpp v20, v26, v20 quad_perm:[2,2,2,2] row_mask:0xf bank_mask:0xf
  v_add_f32_dpp v21, v30, v21 quad_perm:[2,2,2,2] row_mask:0xf bank_mask:0xf
  v_add_f32_dpp v22, v34, v22 quad_perm:[2,2,2,2] row_mask:0xf bank_mask:0xf
  v_add_f32_dpp v23, v38, v23 quad_perm:[2,2,2,2] row_mask:0xf bank_mask:0xf
  v_add_f32_dpp v20, v27, v20 quad_perm:[3,3,3,3] row_mask:0xf bank_mask:0xf
  v_add_f32_dpp v21, v31, v21 quad_perm:[3,3,3,3] row_mask:0xf bank_mask:0xf
  v_add_f32_dpp v22, v35, v22 quad_perm:[3,3,3,3] row_mask:0xf bank_mask:0xf
  v_add_f32_dpp v23, v39, v23 quad_perm:[3,3,3,3] row_mask:0xf bank_mask:0xf
  ds_write_b128 v2, v[20:23] offset:0
  v_max3_f32 v16, v16, v20, v21
  v_max3_f32 v16, v16, v22, v23
  s_waitcnt vmcnt(7)
  s_cbranch_vccz L_wl2
  s_cbranch_scc1 L_wd2
  s_waitcnt vmcnt(6)
  s_branch L_wd2
L_wl2:
  s_waitcnt vmcnt(5)
  s_cbranch_scc1 L_wd2
  s_waitcnt vmcnt(4)
L_wd2:
  buffer_load_dwordx4 v[44:47], v1, s[20:23], s48 offen offset:512 nt
  s_waitcnt vmcnt(7)
  s_cbranch_vccz L_wl3
  s_cbranch_scc1 L_wd3
  s_waitcnt vmcnt(6)
  s_branch L_wd3
L_wl3:
  s_waitcnt vmcnt(5)
  s_cbranch_scc1 L_wd3
  s_waitcnt vmcnt(4)
L_wd3:
  buffer_load_dwordx4 v[48:51], v1, s[20:23], s48 offen offset:1024 nt
  s_waitcnt vmcnt(7)
  s_cbranch_vccz L_wl4
  s_cbranch_scc1 L_wd4
  s_waitcnt vmcnt(6)
  s_branch L_wd4
L_wl4:
  s_waitcnt vmcnt(5)
  s_cbranch_scc1 L_wd4
  s_waitcnt vmcnt(4)
L_wd4:
  buffer_load_dwordx4 v[52:55], v1, s[20:23], s48 offen offset:1536 nt
  s_waitcnt vmcnt(15)
  v_mfma_f32_16x16x32_bf16 v[24:27], v[56:59], v[4:7], 0
  s_waitcnt vmcnt(14)
  v_mfma_f32_16x16x32_bf16 v[28:31], v[60:63], v[4:7], 0
  s_waitcnt vmcnt(13)
  v_mfma_f32_16x16x32_bf16 v[32:35], v[64:67], v[4:7], 0
  s_waitcnt vmcnt(12)
  v_mfma_f32_16x16x32_bf16 v[36:39], v[68:71], v[4:7], 0
  s_waitcnt vmcnt(7)
  s_cbranch_vccz L_wl5
  s_cbranch_scc1 L_wd5
  s_waitcnt vmcnt(6)
  s_branch L_wd5
L_wl5:
  s_waitcnt vmcnt(5)
  s_cbranch_scc1 L_wd5
  s_waitcnt vmcnt(4)
L_wd5:
  buffer_load_dwordx4 v[56:59], v1, s[20:23], s49 offen offset:0 nt
  s_nop 4
  v_mov_b32_dpp v20, v24 quad_perm:[0,0,0,0] row_mask:0xf bank_mask:0xf
  v_mov_b32_dpp v21, v28 quad_perm:[0,0,0,0] row_mask:0xf bank_mask:0xf
  v_mov_b32_dpp v22, v32 quad_perm:[0,0,0,0] row_mask:0xf bank_mask:0xf
  v_mov_b32_dpp v23, v36 quad_perm:[0,0,0,0] row_mask:0xf bank_mask:0xf
  v_add_f32_dpp v20, v25, v20 quad_perm:[1,1,1,1] row_mask:0xf bank_mask:0xf
  v_add_f32_dpp v21, v29, v21 quad_perm:[1,1,1,1] row_mask:0xf bank_mask:0xf
  v_add_f32_dpp v22, v33, v22 quad_perm:[1,1,1,1] row_mask:0xf bank_mask:0xf
  v_add_f32_dpp v23, v37, v23 quad_perm:[1,1,1,1] row_mask:0xf bank_mask:0xf
  v_add_f32_dpp v20, v26, v20 quad_perm:[2,2,2,2] row_mask:0xf bank_mask:0xf
  v_add_f32_dpp v21, v30, v21 quad_perm:[2,2,2,2] row_mask:0xf bank_mask:0xf
  v_add_f32_dpp v22, v34, v22 quad_perm:[2,2,2,2] row_mask:0xf bank_mask:0xf
  v_add_f32_dpp v23, v38, v23 quad_perm:[2,2,2,2] row_mask:0xf bank_mask:0xf
  v_add_f32_dpp v20, v27, v20 quad_perm:[3,3,3,3] row_mask:0xf bank_mask:0xf
  v_add_f32_dpp v21, v31, v21 quad_perm:[3,3,3,3] row_mask:0xf bank_mask:0xf
  v_add_f32_dpp v22, v35, v22 quad_perm:[3,3,3,3] row_mask:0xf bank_mask:0xf
  v_add_f32_dpp v23, v39, v23 quad_perm:[3,3,3,3] row_mask:0xf bank_mask:0xf
  ds_write_b128 v2, v[20:23] offset:128
  v_max3_f32 v16, v16, v20, v21
  v_max3_f32 v16, v16, v22, v23
  s_cmp_lg_u32 s57, 0
  s_cbranch_scc1 L_first
  s_bitcmp1_b32 s46, 0
  s_waitcnt vmcnt(7)
  s_cbranch_vccz L_wl6
  s_cbranch_scc1 L_wd6
  s_waitcnt vmcnt(6)
  s_branch L_wd6
L_wl6:
  s_waitcnt vmcnt(5)
  s_cbranch_scc1 L_wd6
  s_waitcnt vmcnt(4)
L_wd6:
  buffer_load_dwordx4 v[60:63], v1, s[20:23], s49 offen offset:512 nt
  s_waitcnt vmcnt(7)
  s_cbranch_vccz L_wl7
  s_cbranch_scc1 L_wd7
  s_waitcnt vmcnt(6)
  s_branch L_wd7
L_wl7:
  s_waitcnt vmcnt(5)
  s_cbranch_scc1 L_wd7
  s_waitcnt vmcnt(4)
L_wd7:
  buffer_load_dwordx4 v[64:67], v1, s[20:23], s49 offen offset:1024 nt
  s_memrealtime s[62:63]
  s_waitcnt vmcnt(7)
  s_cbranch_vccz L_wl8
  s_cbranch_scc1 L_wd8
  s_waitcnt vmcnt(6)
  s_branch L_wd8
L_wl8:
  s_waitcnt vmcnt(5)
  s_cbranch_scc1 L_wd8
  s_waitcnt vmcnt(4)
L_wd8:
  buffer_load_dwordx4 v[68:71], v1, s[20:23], s49 offen offset:1536 nt
L_kk1:
  s_mov_b32 s48, s59
  s_add_u32 s49, s59, 65536
  s_add_u32 s59, s59, 131072
  s_waitcnt lgkmcnt(0)
  s_sub_u32 s43, s62, s42
  s_cmp_gt_i32 s43, 0
  s_cselect_b32 s46, 1, 0
  s_cmp_gt_i32 s43, s53
  s_addc_u32 s46, s46, 0
  s_cmp_gt_i32 s43, s52
  s_cselect_b64 vcc, -1, 0
  s_addc_u32 s46, s46, 0
  s_addk_i32 s42, 108
  s_addk_i32 s52, 3
  s_addk_i32 s53, 7
  s_bitcmp1_b32 s46, 0
  s_waitcnt vmcnt(15)
  v_mfma_f32_16x16x32_bf16 v[24:27], v[72:75], v[4:7], 0
  s_waitcnt vmcnt(14)
  v_mfma_f32_16x16x32_bf16 v[28:31], v[76:79], v[4:7], 0
  s_waitcnt vmcnt(13)
  v_mfma_f32_16x16x32_bf16 v[32:35], v[80:83], v[4:7], 0
  s_waitcnt vmcnt(12)
  v_mfma_f32_16x16x32_bf16 v[36:39], v[84:87], v[4:7], 0
  s_waitcnt vmcnt(7)
  s_cbranch_vccz L_wl9
  s_cbranch_scc1 L_wd9
  s_waitcnt vmcnt(6)
  s_branch L_wd9
L_wl9:
  s_waitcnt vmcnt(5)
  s_cbranch_scc1 L_wd9
  s_waitcnt vmcnt(4)
L_wd9:
  buffer_load_dwordx4 v[72:75], v1, s[20:23], s48 offen offset:0 nt
  s_nop 4
  v_mov_b32_dpp v20, v24 quad_perm:[0,0,0,0] row_mask:0xf bank_mask:0xf
  v_mov_b32_dpp v21, v28 quad_perm:[0,0,0,0] row_mask:0xf bank_mask:0xf
  v_mov_b32_dpp v22, v32 quad_perm:[0,0,0,0] row_mask:0xf bank_mask:0xf
  v_mov_b32_dpp v23, v36 quad_perm:[0,0,0,0] row_mask:0xf bank_mask:0xf
  v_add_f32_dpp v20, v25, v20 quad_perm:[1,1,1,1] row_mask:0xf bank_mask:0xf
  v_add_f32_dpp v21, v29, v21 quad_perm:[1,1,1,1] row_mask:0xf bank_mask:0xf
  v_add_f32_dpp v22, v33, v22 quad_perm:[1,1,1,1] row_mask:0xf bank_mask:0xf
  v_add_f32_dpp v23, v37, v23 quad_perm:[1,1,1,1] row_mask:0xf bank_mask:0xf
  v_add_f32_dpp v20, v26, v20 quad_perm:[2,2,2,2] row_mask:0xf bank_mask:0xf
  v_add_f32_dpp v21, v30, v21 quad_perm:[2,2,2,2] row_mask:0xf bank_mask:0xf
  v_add_f32_dpp v22, v34, v22 quad_perm:[2,2,2,2] row_mask:0xf bank_mask:0xf
  v_add_f32_dpp v23, v38, v23 quad_perm:[2,2,2,2] row_mask:0xf bank_mask:0xf
  v_add_f32_dpp v20, v27, v20 quad_perm:[3,3,3,3] row_mask:0xf bank_mask:0xf
  v_add_f32_dpp v21, v31, v21 quad_perm:[3,3,3,3] row_mask:0xf bank_mask:0xf
  v_add_f32_dpp v22, v35, v22 quad_perm:[3,3,3,3] row_mask:0xf bank_mask:0xf
  v_add_f32_dpp v23, v39, v23 quad_perm:[3,3,3,3] row_mask:0xf bank_mask:0xf
  ds_write_b128 v2, v[20:23] offset:256
  v_max3_f32 v16, v16, v20, v21
  v_max3_f32 v16, v16, v22, v23
  s_waitcnt vmcnt(7)
  s_cbranch_vccz L_wl10
  s_cbranch_scc1 L_wd10
  s_waitcnt vmcnt(6)
  s_branch L_wd10
L_wl10:
  s_waitcnt vmcnt(5)
  s_cbranch_scc1 L_wd10
  s_waitcnt vmcnt(4)
L_wd10:
  buffer_load_dwordx4 v[76:79], v1, s[20:23], s48 offen offset:512 nt
  s_waitcnt vmcnt(7)
  s_cbranch_vccz L_wl11
  s_cbranch_scc1 L_wd11
  s_waitcnt vmcnt(6)
  s_branch L_wd11
L_wl11:
  s_waitcnt vmcnt(5)
  s_cbranch_scc1 L_wd11
  s_waitcnt vmcnt(4)
L_wd11:
  buffer_load_dwordx4 v[80:83], v1, s[20:23], s48 offen offset:1024 nt
  s_waitcnt vmcnt(7)
  s_cbranch_vccz L_wl12
  s_cbranch_scc1 L_wd12
  s_waitcnt vmcnt(6)
  s_branch L_wd12
L_wl12:
  s_waitcnt vmcnt(5)
  s_cbranch_scc1 L_wd12
  s_waitcnt vmcnt(4)
L_wd12:
  buffer_load_dwordx4 v[84:87], v1, s[20:23], s48 offen offset:1536 nt
  s_waitcnt vmcnt(15)
  v_mfma_f32_16x16x32_bf16 v[24:27], v[88:91], v[4:7], 0
  s_waitcnt vmcnt(14)
  v_mfma_f32_16x16x32_bf16 v[28:31], v[92:95], v[4:7], 0
  s_waitcnt vmcnt(13)
  v_mfma_f32_16x16x32_bf16 v[32:35], v[96:99], v[4:7], 0
  s_waitcnt vmcnt(12)
  v_mfma_f32_16x16x32_bf16 v[36:39], v[100:103], v[4:7], 0
  s_waitcnt vmcnt(7)
  s_cbranch_vccz L_wl13
  s_cbranch_scc1 L_wd13
  s_waitcnt vmcnt(6)
  s_branch L_wd13
L_wl13:
  s_waitcnt vmcnt(5)
  s_cbranch_scc1 L_wd13
  s_waitcnt vmcnt(4)
L_wd13:
  buffer_load_dwordx4 v[88:91], v1, s[20:23], s49 offen offset:0 nt
  s_nop 4
  v_mov_b32_dpp v20, v24 quad_perm:[0,0,0,0] row_mask:0xf bank_mask:0xf
  v_mov_b32_dpp v21, v28 quad_perm:[0,0,0,0] row_mask:0xf bank_mask:0xf
  v_mov_b32_dpp v22, v32 quad_perm:[0,0,0,0] row_mask:0xf bank_mask:0xf
  v_mov_b32_dpp v23, v36 quad_perm:[0,0,0,0] row_mask:0xf bank_mask:0xf
  v_add_f32_dpp v20, v25, v20 quad_perm:[1,1,1,1] row_mask:0xf bank_mask:0xf
  v_add_f32_dpp v21, v29, v21 quad_perm:[1,1,1,1] row_mask:0xf bank_mask:0xf
  v_add_f32_dpp v22, v33, v22 quad_perm:[1,1,1,1] row_mask:0xf bank_mask:0xf
  v_add_f32_dpp v23, v37, v23 quad_perm:[1,1,1,1] row_mask:0xf bank_mask:0xf
  v_add_f32_dpp v20, v26, v20 quad_perm:[2,2,2,2] row_mask:0xf bank_mask:0xf
  v_add_f32_dpp v21, v30, v21 quad_perm:[2,2,2,2] row_mask:0xf bank_mask:0xf
  v_add_f32_dpp v22, v34, v22 quad_perm:[2,2,2,2] row_mask:0xf bank_mask:0xf
  v_add_f32_dpp v23, v38, v23 quad_perm:[2,2,2,2] row_mask:0xf bank_mask:0xf
  v_add_f32_dpp v20, v27, v20 quad_perm:[3,3,3,3] row_mask:0xf bank_mask:0xf
  v_add_f32_dpp v21, v31, v21 quad_perm:[3,3,3,3] row_mask:0xf bank_mask:0xf
  v_add_f32_dpp v22, v35, v22 quad_perm:[3,3,3,3] row_mask:0xf bank_mask:0xf
  v_add_f32_dpp v23, v39, v23 quad_perm:[3,3,3,3] row_mask:0xf bank_mask:0xf
  ds_write_b128 v2, v[20:23] offset:384
  v_max3_f32 v16, v16, v20, v21
  v_max3_f32 v16, v16, v22, v23
  s_waitcnt vmcnt(7)
  s_cbranch_vccz L_wl14
  s_cbranch_scc1 L_wd14
  s_waitcnt vmcnt(6)
  s_branch L_wd14
L_wl14:
  s_waitcnt vmcnt(5)
  s_cbranch_scc1 L_wd14
  s_waitcnt vmcnt(4)
L_wd14:
  buffer_load_dwordx4 v[92:95], v1, s[20:23], s49 offen offset:512 nt
  s_waitcnt vmcnt(7)
  s_cbranch_vccz L_wl15
  s_cbranch_scc1 L_wd15
  s_waitcnt vmcnt(6)
  s_branch L_wd15
L_wl15:
  s_waitcnt vmcnt(5)
  s_cbranch_scc1 L_wd15
  s_waitcnt vmcnt(4)
L_wd15:
  buffer_load_dwordx4 v[96:99], v1, s[20:23], s49 offen offset:1024 nt
  s_memrealtime s[62:63]
  s_waitcnt vmcnt(7)
  s_cbranch_vccz L_wl16
  s_cbranch_scc1 L_wd16
  s_waitcnt vmcnt(6)
  s_branch L_wd16
L_wl16:
  s_waitcnt vmcnt(5)
  s_cbranch_scc1 L_wd16
  s_waitcnt vmcnt(4)
L_wd16:
  buffer_load_dwordx4 v[100:103], v1, s[20:23], s49 offen offset:1536 nt
  v_add_u32 v2, 512, v2
  s_sub_u32 s38, s38, 1
  s_cmp_lg_u32 s38, 0
  s_cbranch_scc1 L_kk
  v_mov_b32 v19, v16
  v_subrev_u32 v2, 4096, v2
  s_mov_b32 s38, 7
  v_permlane32_swap_b32 v16, v19
  v_max_f32 v16, v16, v19
  v_mov_b32 v19, v16
  ds_write_b32 v114, v115 offset:24
  s_nop 0
  v_permlane16_swap_b32 v16, v19
  v_max_f32 v16, v16, v19
L_vv:
  ds_read_b128 v[20:23], v2 offset:0
  ds_read_b128 v[124:127], v2 offset:128
  s_mov_b32 s48, s59
  s_add_u32 s49, s59, 65536
  s_add_u32 s59, s59, 131072
  s_waitcnt lgkmcnt(0)
  s_sub_u32 s43, s62, s42
  s_cmp_gt_i32 s43, 0
  s_cselect_b32 s46, 1, 0
  s_cmp_gt_i32 s43, s53
  s_addc_u32 s46, s46, 0
  s_cmp_gt_i32 s43, s52
  s_cselect_b64 vcc, -1, 0
  s_addc_u32 s46, s46, 0
  s_addk_i32 s42, 108
  s_addk_i32 s52, 3
  s_addk_i32 s53, 7
  s_bitcmp1_b32 s46, 0
  v_sub_f32 v20, v20, v16
  v_sub_f32 v21, v21, v16
  v_sub_f32 v22, v22, v16
  v_sub_f32 v23, v23, v16
  v_mul_f32 v20, s41, v20
  v_mul_f32 v21, s41, v21
  v_mul_f32 v22, s41, v22
  v_mul_f32 v23, s41, v23
  v_exp_f32 v20, v20
  v_exp_f32 v21, v21
  v_exp_f32 v22, v22
  v_exp_f32 v23, v23
  v_cvt_pk_bf16_f32 v3, v20, v20
  v_and_b32 v24, v3, v8
  v_and_b32 v25, v3, v9
  v_and_b32 v26, v3, v10
  v_and_b32 v27, v3, v11
  v_add_f32 v17, v17, v20
  v_cvt_pk_bf16_f32 v3, v21, v21
  v_and_b32 v28, v3, v8
  v_and_b32 v29, v3, v9
  v_and_b32 v30, v3, v10
  v_and_b32 v31, v3, v11
  v_add_f32 v17, v17, v21
  v_cvt_pk_bf16_f32 v3, v22, v22
  v_and_b32 v32, v3, v8
  v_and_b32 v33, v3, v9
  v_and_b32 v34, v3, v10
  v_and_b32 v35, v3, v11
  v_add_f32 v17, v17, v22
  v_cvt_pk_bf16_f32 v3, v23, v23
  v_and_b32 v36, v3, v8
  v_and_b32 v37, v3, v9
  v_and_b32 v38, v3, v10
  v_and_b32 v39, v3, v11
  v_add_f32 v17, v17, v23
  s_waitcnt vmcnt(15)
  v_mfma_f32_16x16x32_bf16 v[12:15], v[40:43], v[24:27], v[12:15]
  s_waitcnt vmcnt(14)
  v_mfma_f32_16x16x32_bf16 v[12:15], v[44:47], v[28:31], v[12:15]
  s_waitcnt vmcnt(13)
  v_mfma_f32_16x16x32_bf16 v[12:15], v[48:51], v[32:35], v[12:15]
  s_waitcnt vmcnt(12)
  v_mfma_f32_16x16x32_bf16 v[12:15], v[52:55], v[36:39], v[12:15]
  s_waitcnt vmcnt(7)
  s_cbranch_vccz L_wl17
  s_cbranch_scc1 L_wd17
  s_waitcnt vmcnt(6)
  s_branch L_wd17
L_wl17:
  s_waitcnt vmcnt(5)
  s_cbranch_scc1 L_wd17
  s_waitcnt vmcnt(4)
L_wd17:
  buffer_load_dwordx4 v[40:43], v1, s[20:23], s48 offen offset:0 nt
  v_sub_f32 v124, v124, v16
  v_sub_f32 v125, v125, v16
  v_sub_f32 v126, v126, v16
  v_sub_f32 v127, v127, v16
  v_mul_f32 v124, s41, v124
  v_mul_f32 v125, s41, v125
  v_mul_f32 v126, s41, v126
  v_mul_f32 v127, s41, v127
  v_exp_f32 v124, v124
  v_exp_f32 v125, v125
  v_exp_f32 v126, v126
  v_exp_f32 v127, v127
  v_cvt_pk_bf16_f32 v3, v124, v124
  v_and_b32 v24, v3, v8
  v_and_b32 v25, v3, v9
  v_and_b32 v26, v3, v10
  v_and_b32 v27, v3, v11
  v_add_f32 v17, v17, v124
  s_waitcnt vmcnt(7)
  s_cbranch_vccz L_wl18
  s_cbranch_scc1 L_wd18
  s_waitcnt vmcnt(6)
  s_branch L_wd18
L_wl18:
  s_waitcnt vmcnt(5)
  s_cbranch_scc1 L_wd18
  s_waitcnt vmcnt(4)
L_wd18:
  buffer_load_dwordx4 v[44:47], v1, s[20:23], s48 offen offset:512 nt
  v_cvt_pk_bf16_f32 v3, v125, v125
  v_and_b32 v28, v3, v8
  v_and_b32 v29, v3, v9
  v_and_b32 v30, v3, v10
  v_and_b32 v31, v3, v11
  v_add_f32 v17, v17, v125
  v_cvt_pk_bf16_f32 v3, v126, v126
  v_and_b32 v32, v3, v8
  v_and_b32 v33, v3, v9
  v_and_b32 v34, v3, v10
  v_and_b32 v35, v3, v11
  v_add_f32 v17, v17, v126
  v_cvt_pk_bf16_f32 v3, v127, v127
  v_and_b32 v36, v3, v8
  v_and_b32 v37, v3, v9
  v_and_b32 v38, v3, v10
  v_and_b32 v39, v3, v11
  v_add_f32 v17, v17, v127
  s_waitcnt vmcnt(7)
  s_cbranch_vccz L_wl19
  s_cbranch_scc1 L_wd19
  s_waitcnt vmcnt(6)
  s_branch L_wd19
L_wl19:
  s_waitcnt vmcnt(5)
  s_cbranch_scc1 L_wd19
  s_waitcnt vmcnt(4)
L_wd19:
  buffer_load_dwordx4 v[48:51], v1, s[20:23], s48 offen offset:1024 nt
  s_waitcnt vmcnt(7)
  s_cbranch_vccz L_wl20
  s_cbranch_scc1 L_wd20
  s_waitcnt vmcnt(6)
  s_branch L_wd20
L_wl20:
  s_waitcnt vmcnt(5)
  s_cbranch_scc1 L_wd20
  s_waitcnt vmcnt(4)
L_wd20:
  buffer_load_dwordx4 v[52:55], v1, s[20:23], s48 offen offset:1536 nt
  s_waitcnt vmcnt(15)
  v_mfma_f32_16x16x32_bf16 v[12:15], v[56:59], v[24:27], v[12:15]
  s_waitcnt vmcnt(14)
  v_mfma_f32_16x16x32_bf16 v[12:15], v[60:63], v[28:31], v[12:15]
  s_waitcnt vmcnt(13)
  v_mfma_f32_16x16x32_bf16 v[12:15], v[64:67], v[32:35], v[12:15]
  s_waitcnt vmcnt(12)
  v_mfma_f32_16x16x32_bf16 v[12:15], v[68:71], v[36:39], v[12:15]
  s_waitcnt vmcnt(7)
  s_cbranch_vccz L_wl21
  s_cbranch_scc1 L_wd21
  s_waitcnt vmcnt(6)
  s_branch L_wd21
L_wl21:
  s_waitcnt vmcnt(5)
  s_cbranch_scc1 L_wd21
  s_waitcnt vmcnt(4)
L_wd21:
  buffer_load_dwordx4 v[56:59], v1, s[20:23], s49 offen offset:0 nt
  s_waitcnt vmcnt(7)
  s_cbranch_vccz L_wl22
  s_cbranch_scc1 L_wd22
  s_waitcnt vmcnt(6)
  s_branch L_wd22
L_wl22:
  s_waitcnt vmcnt(5)
  s_cbranch_scc1 L_wd22
  s_waitcnt vmcnt(4)
L_wd22:
  buffer_load_dwordx4 v[60:63], v1, s[20:23], s49 offen offset:512 nt
  s_waitcnt vmcnt(7)
  s_cbranch_vccz L_wl23
  s_cbranch_scc1 L_wd23
  s_waitcnt vmcnt(6)
  s_branch L_wd23
L_wl23:
  s_waitcnt vmcnt(5)
  s_cbranch_scc1 L_wd23
  s_waitcnt vmcnt(4)
L_wd23:
  buffer_load_dwordx4 v[64:67], v1, s[20:23], s49 offen offset:1024 nt
  s_memrealtime s[62:63]
  s_waitcnt vmcnt(7)
  s_cbranch_vccz L_wl24
  s_cbranch_scc1 L_wd24
  s_waitcnt vmcnt(6)
  s_branch L_wd24
L_wl24:
  s_waitcnt vmcnt(5)
  s_cbranch_scc1 L_wd24
  s_waitcnt vmcnt(4)
L_wd24:
  buffer_load_dwordx4 v[68:71], v1, s[20:23], s49 offen offset:1536 nt
  ds_read_b128 v[20:23], v2 offset:256
  ds_read_b128 v[124:127], v2 offset:384
  s_mov_b32 s48, s59
  s_add_u32 s49, s59, 65536
  s_add_u32 s59, s59, 131072
  s_waitcnt lgkmcnt(0)
  s_sub_u32 s43, s62, s42
  s_cmp_gt_i32 s43, 0
  s_cselect_b32 s46, 1, 0
  s_cmp_gt_i32 s43, s53
  s_addc_u32 s46, s46, 0
  s_cmp_gt_i32 s43, s52
  s_cselect_b64 vcc, -1, 0
  s_addc_u32 s46, s46, 0
  s_addk_i32 s42, 108
  s_addk_i32 s52, 3
  s_addk_i32 s53, 7
  s_bitcmp1_b32 s46, 0
  v_sub_f32 v20, v20, v16
  v_sub_f32 v21, v21, v16
  v_sub_f32 v22, v22, v16
  v_sub_f32 v23, v23, v16
  v_mul_f32 v20, s41, v20
  v_mul_f32 v21, s41, v21
  v_mul_f32 v22, s41, v22
  v_mul_f32 v23, s41, v23
  v_exp_f32 v20, v20
  v_exp_f32 v21, v21
  v_exp_f32 v22, v22
  v_exp_f32 v23, v23
  v_cvt_pk_bf16_f32 v3, v20, v20
  v_and_b32 v24, v3, v8
  v_and_b32 v25, v3, v9
  v_and_b32 v26, v3, v10
  v_and_b32 v27, v3, v11
  v_add_f32 v17, v17, v20
  v_cvt_pk_bf16_f32 v3, v21, v21
  v_and_b32 v28, v3, v8
  v_and_b32 v29, v3, v9
  v_and_b32 v30, v3, v10
  v_and_b32 v31, v3, v11
  v_add_f32 v17, v17, v21
  v_cvt_pk_bf16_f32 v3, v22, v22
  v_and_b32 v32, v3, v8
  v_and_b32 v33, v3, v9
  v_and_b32 v34, v3, v10
  v_and_b32 v35, v3, v11
  v_add_f32 v17, v17, v22
  v_cvt_pk_bf16_f32 v3, v23, v23
  v_and_b32 v36, v3, v8
  v_and_b32 v37, v3, v9
  v_and_b32 v38, v3, v10
  v_and_b32 v39, v3, v11
  v_add_f32 v17, v17, v23
  s_waitcnt vmcnt(15)
  v_mfma_f32_16x16x32_bf16 v[12:15], v[72:75], v[24:27], v[12:15]
  s_waitcnt vmcnt(14)
  v_mfma_f32_16x16x32_bf16 v[12:15], v[76:79], v[28:31], v[12:15]
  s_waitcnt vmcnt(13)
  v_mfma_f32_16x16x32_bf16 v[12:15], v[80:83], v[32:35], v[12:15]
  s_waitcnt vmcnt(12)
  v_mfma_f32_16x16x32_bf16 v[12:15], v[84:87], v[36:39], v[12:15]
  s_waitcnt vmcnt(7)
  s_cbranch_vccz L_wl25
  s_cbranch_scc1 L_wd25
  s_waitcnt vmcnt(6)
  s_branch L_wd25
L_wl25:
  s_waitcnt vmcnt(5)
  s_cbranch_scc1 L_wd25
  s_waitcnt vmcnt(4)
L_wd25:
  buffer_load_dwordx4 v[72:75], v1, s[20:23], s48 offen offset:0 nt
  v_sub_f32 v124, v124, v16
  v_sub_f32 v125, v125, v16
  v_sub_f32 v126, v126, v16
  v_sub_f32 v127, v127, v16
  v_mul_f32 v124, s41, v124
  v_mul_f32 v125, s41, v125
  v_mul_f32 v126, s41, v126
  v_mul_f32 v127, s41, v127
  v_exp_f32 v124, v124
  v_exp_f32 v125, v125
  v_exp_f32 v126, v126
  v_exp_f32 v127, v127
  v_cvt_pk_bf16_f32 v3, v124, v124
  v_and_b32 v24, v3, v8
  v_and_b32 v25, v3, v9
  v_and_b32 v26, v3, v10
  v_and_b32 v27, v3, v11
  v_add_f32 v17, v17, v124
  s_waitcnt vmcnt(7)
  s_cbranch_vccz L_wl26
  s_cbranch_scc1 L_wd26
  s_waitcnt vmcnt(6)
  s_branch L_wd26
L_wl26:
  s_waitcnt vmcnt(5)
  s_cbranch_scc1 L_wd26
  s_waitcnt vmcnt(4)
L_wd26:
  buffer_load_dwordx4 v[76:79], v1, s[20:23], s48 offen offset:512 nt
  v_cvt_pk_bf16_f32 v3, v125, v125
  v_and_b32 v28, v3, v8
  v_and_b32 v29, v3, v9
  v_and_b32 v30, v3, v10
  v_and_b32 v31, v3, v11
  v_add_f32 v17, v17, v125
  v_cvt_pk_bf16_f32 v3, v126, v126
  v_and_b32 v32, v3, v8
  v_and_b32 v33, v3, v9
  v_and_b32 v34, v3, v10
  v_and_b32 v35, v3, v11
  v_add_f32 v17, v17, v126
  v_cvt_pk_bf16_f32 v3, v127, v127
  v_and_b32 v36, v3, v8
  v_and_b32 v37, v3, v9
  v_and_b32 v38, v3, v10
  v_and_b32 v39, v3, v11
  v_add_f32 v17, v17, v127
  s_waitcnt vmcnt(7)
  s_cbranch_vccz L_wl27
  s_cbranch_scc1 L_wd27
  s_waitcnt vmcnt(6)
  s_branch L_wd27
L_wl27:
  s_waitcnt vmcnt(5)
  s_cbranch_scc1 L_wd27
  s_waitcnt vmcnt(4)
L_wd27:
  buffer_load_dwordx4 v[80:83], v1, s[20:23], s48 offen offset:1024 nt
  s_waitcnt vmcnt(7)
  s_cbranch_vccz L_wl28
  s_cbranch_scc1 L_wd28
  s_waitcnt vmcnt(6)
  s_branch L_wd28
L_wl28:
  s_waitcnt vmcnt(5)
  s_cbranch_scc1 L_wd28
  s_waitcnt vmcnt(4)
L_wd28:
  buffer_load_dwordx4 v[84:87], v1, s[20:23], s48 offen offset:1536 nt
  s_waitcnt vmcnt(15)
  v_mfma_f32_16x16x32_bf16 v[12:15], v[88:91], v[24:27], v[12:15]
  s_waitcnt vmcnt(14)
  v_mfma_f32_16x16x32_bf16 v[12:15], v[92:95], v[28:31], v[12:15]
  s_waitcnt vmcnt(13)
  v_mfma_f32_16x16x32_bf16 v[12:15], v[96:99], v[32:35], v[12:15]
  s_waitcnt vmcnt(12)
  v_mfma_f32_16x16x32_bf16 v[12:15], v[100:103], v[36:39], v[12:15]
  s_waitcnt vmcnt(7)
  s_cbranch_vccz L_wl29
  s_cbranch_scc1 L_wd29
  s_waitcnt vmcnt(6)
  s_branch L_wd29
L_wl29:
  s_waitcnt vmcnt(5)
  s_cbranch_scc1 L_wd29
  s_waitcnt vmcnt(4)
L_wd29:
  buffer_load_dwordx4 v[88:91], v1, s[20:23], s49 offen offset:0 nt
  s_waitcnt vmcnt(7)
  s_cbranch_vccz L_wl30
  s_cbranch_scc1 L_wd30
  s_waitcnt vmcnt(6)
  s_branch L_wd30
L_wl30:
  s_waitcnt vmcnt(5)
  s_cbranch_scc1 L_wd30
  s_waitcnt vmcnt(4)
L_wd30:
  buffer_load_dwordx4 v[92:95], v1, s[20:23], s49 offen offset:512 nt
  s_waitcnt vmcnt(7)
  s_cbranch_vccz L_wl31
  s_cbranch_scc1 L_wd31
  s_waitcnt vmcnt(6)
  s_branch L_wd31
L_wl31:
  s_waitcnt vmcnt(5)
  s_cbranch_scc1 L_wd31
  s_waitcnt vmcnt(4)
L_wd31:
  buffer_load_dwordx4 v[96:99], v1, s[20:23], s49 offen offset:1024 nt
  s_memrealtime s[62:63]
  s_waitcnt vmcnt(7)
  s_cbranch_vccz L_wl32
  s_cbranch_scc1 L_wd32
  s_waitcnt vmcnt(6)
  s_branch L_wd32
L_wl32:
  s_waitcnt vmcnt(5)
  s_cbranch_scc1 L_wd32
  s_waitcnt vmcnt(4)
L_wd32:
  buffer_load_dwordx4 v[100:103], v1, s[20:23], s49 offen offset:1536 nt
  v_add_u32 v2, 512, v2
  s_sub_u32 s38, s38, 1
  s_cmp_lg_u32 s38, 0
  s_cbranch_scc1 L_vv
  s_mov_b64 exec, 1
  ds_add_u32 v114, v115 offset:8
  s_mov_b64 exec, -1
  ds_read_b128 v[20:23], v2 offset:0
  ds_read_b128 v[124:127], v2 offset:128
  s_waitcnt lgkmcnt(0)
  v_sub_f32 v20, v20, v16
  v_sub_f32 v21, v21, v16
  v_sub_f32 v22, v22, v16
  v_sub_f32 v23, v23, v16
  v_mul_f32 v20, s41, v20
  v_mul_f32 v21, s41, v21
  v_mul_f32 v22, s41, v22
  v_mul_f32 v23, s41, v23
  v_exp_f32 v20, v20
  v_exp_f32 v21, v21
  v_exp_f32 v22, v22
  v_exp_f32 v23, v23
  v_cvt_pk_bf16_f32 v3, v20, v20
  v_and_b32 v24, v3, v8
  v_and_b32 v25, v3, v9
  v_and_b32 v26, v3, v10
  v_and_b32 v27, v3, v11
  v_add_f32 v17, v17, v20
  v_cvt_pk_bf16_f32 v3, v21, v21
  v_and_b32 v28, v3, v8
  v_and_b32 v29, v3, v9
  v_and_b32 v30, v3, v10
  v_and_b32 v31, v3, v11
  v_add_f32 v17, v17, v21
  v_cvt_pk_bf16_f32 v3, v22, v22
  v_and_b32 v32, v3, v8
  v_and_b32 v33, v3, v9
  v_and_b32 v34, v3, v10
  v_and_b32 v35, v3, v11
  v_add_f32 v17, v17, v22
  v_cvt_pk_bf16_f32 v3, v23, v23
  v_and_b32 v36, v3, v8
  v_and_b32 v37, v3, v9
  v_and_b32 v38, v3, v10
  v_and_b32 v39, v3, v11
  v_add_f32 v17, v17, v23
  s_waitcnt vmcnt(15)
  v_mfma_f32_16x16x32_bf16 v[12:15], v[40:43], v[24:27], v[12:15]
  s_waitcnt vmcnt(14)
  v_mfma_f32_16x16x32_bf16 v[12:15], v[44:47], v[28:31], v[12:15]
  s_waitcnt vmcnt(13)
  v_mfma_f32_16x16x32_bf16 v[12:15], v[48:51], v[32:35], v[12:15]
  s_waitcnt vmcnt(12)
  v_mfma_f32_16x16x32_bf16 v[12:15], v[52:55], v[36:39], v[12:15]
  v_sub_f32 v124, v124, v16
  v_sub_f32 v125, v125, v16
  v_sub_f32 v126, v126, v16
  v_sub_f32 v127, v127, v16
  v_mul_f32 v124, s41, v124
  v_mul_f32 v125, s41, v125
  v_mul_f32 v126, s41, v126
  v_mul_f32 v127, s41, v127
  v_exp_f32 v124, v124
  v_exp_f32 v125, v125
  v_exp_f32 v126, v126
  v_exp_f32 v127, v127
  v_cvt_pk_bf16_f32 v3, v124, v124
  v_and_b32 v24, v3, v8
  v_and_b32 v25, v3, v9
  v_and_b32 v26, v3, v10
  v_and_b32 v27, v3, v11
  v_add_f32 v17, v17, v124
  v_cvt_pk_bf16_f32 v3, v125, v125
  v_and_b32 v28, v3, v8
  v_and_b32 v29, v3, v9
  v_and_b32 v30, v3, v10
  v_and_b32 v31, v3, v11
  v_add_f32 v17, v17, v125
  v_cvt_pk_bf16_f32 v3, v126, v126
  v_and_b32 v32, v3, v8
  v_and_b32 v33, v3, v9
  v_and_b32 v34, v3, v10
  v_and_b32 v35, v3, v11
  v_add_f32 v17, v17, v126
  v_cvt_pk_bf16_f32 v3, v127, v127
  v_and_b32 v36, v3, v8
  v_and_b32 v37, v3, v9
  v_and_b32 v38, v3, v10
  v_and_b32 v39, v3, v11
  v_add_f32 v17, v17, v127
  s_waitcnt vmcnt(11)
  v_mfma_f32_16x16x32_bf16 v[12:15], v[56:59], v[24:27], v[12:15]
  s_waitcnt vmcnt(10)
  v_mfma_f32_16x16x32_bf16 v[12:15], v[60:63], v[28:31], v[12:15]
  s_waitcnt vmcnt(9)
  v_mfma_f32_16x16x32_bf16 v[12:15], v[64:67], v[32:35], v[12:15]
  s_waitcnt vmcnt(8)
  v_mfma_f32_16x16x32_bf16 v[12:15], v[68:71], v[36:39], v[12:15]
  ds_read_b128 v[20:23], v2 offset:256
  ds_read_b128 v[124:127], v2 offset:384
  s_waitcnt lgkmcnt(0)
  v_sub_f32 v20, v20, v16
  v_sub_f32 v21, v21, v16
  v_sub_f32 v22, v22, v16
  v_sub_f32 v23, v23, v16
  v_mul_f32 v20, s41, v20
  v_mul_f32 v21, s41, v21
  v_mul_f32 v22, s41, v22
  v_mul_f32 v23, s41, v23
  v_exp_f32 v20, v20
  v_exp_f32 v21, v21
  v_exp_f32 v22, v22
  v_exp_f32 v23, v23
  v_cvt_pk_bf16_f32 v3, v20, v20
  v_and_b32 v24, v3, v8
  v_and_b32 v25, v3, v9
  v_and_b32 v26, v3, v10
  v_and_b32 v27, v3, v11
  v_add_f32 v17, v17, v20
  v_cvt_pk_bf16_f32 v3, v21, v21
  v_and_b32 v28, v3, v8
  v_and_b32 v29, v3, v9
  v_and_b32 v30, v3, v10
  v_and_b32 v31, v3, v11
  v_add_f32 v17, v17, v21
  v_cvt_pk_bf16_f32 v3, v22, v22
  v_and_b32 v32, v3, v8
  v_and_b32 v33, v3, v9
  v_and_b32 v34, v3, v10
  v_and_b32 v35, v3, v11
  v_add_f32 v17, v17, v22
  v_cvt_pk_bf16_f32 v3, v23, v23
  v_and_b32 v36, v3, v8
  v_and_b32 v37, v3, v9
  v_and_b32 v38, v3, v10
  v_and_b32 v39, v3, v11
  v_add_f32 v17, v17, v23
  s_waitcnt vmcnt(7)
  v_mfma_f32_16x16x32_bf16 v[12:15], v[72:75], v[24:27], v[12:15]
  s_waitcnt vmcnt(6)
  v_mfma_f32_16x16x32_bf16 v[12:15], v[76:79], v[28:31], v[12:15]
  s_waitcnt vmcnt(5)
  v_mfma_f32_16x16x32_bf16 v[12:15], v[80:83], v[32:35], v[12:15]
  s_waitcnt vmcnt(4)
  v_mfma_f32_16x16x32_bf16 v[12:15], v[84:87], v[36:39], v[12:15]
  v_sub_f32 v124, v124, v16
  v_sub_f32 v125, v125, v16
  v_sub_f32 v126, v126, v16
  v_sub_f32 v127, v127, v16
  v_mul_f32 v124, s41, v124
  v_mul_f32 v125, s41, v125
  v_mul_f32 v126, s41, v126
  v_mul_f32 v127, s41, v127
  v_exp_f32 v124, v124
  v_exp_f32 v125, v125
  v_exp_f32 v126, v126
  v_exp_f32 v127, v127
  v_cvt_pk_bf16_f32 v3, v124, v124
  v_and_b32 v24, v3, v8
  v_and_b32 v25, v3, v9
  v_and_b32 v26, v3, v10
  v_and_b32 v27, v3, v11
  v_add_f32 v17, v17, v124
  v_cvt_pk_bf16_f32 v3, v125, v125
  v_and_b32 v28, v3, v8
  v_and_b32 v29, v3, v9
  v_and_b32 v30, v3, v10
  v_and_b32 v31, v3, v11
  v_add_f32 v17, v17, v125
  v_cvt_pk_bf16_f32 v3, v126, v126
  v_and_b32 v32, v3, v8
  v_and_b32 v33, v3, v9
  v_and_b32 v34, v3, v10
  v_and_b32 v35, v3, v11
  v_add_f32 v17, v17, v126
  v_cvt_pk_bf16_f32 v3, v127, v127
  v_and_b32 v36, v3, v8
  v_and_b32 v37, v3, v9
  v_and_b32 v38, v3, v10
  v_and_b32 v39, v3, v11
  v_add_f32 v17, v17, v127
  v_mov_b32 v19, v17
  s_nop 0
  v_mov_b32 v23, s40
  v_permlane32_swap_b32 v17, v19
  v_add_f32 v17, v17, v19
  v_mov_b32 v19, v17
  s_nop 1
  v_permlane16_swap_b32 v17, v19
  v_add_f32 v17, v17, v19
  ds_write_b64 v105, v[16:17]
  s_waitcnt vmcnt(3)
  v_mfma_f32_16x16x32_bf16 v[12:15], v[88:91], v[24:27], v[12:15]
  s_waitcnt vmcnt(2)
  v_mfma_f32_16x16x32_bf16 v[12:15], v[92:95], v[28:31], v[12:15]
  s_waitcnt vmcnt(1)
  v_mfma_f32_16x16x32_bf16 v[12:15], v[96:99], v[32:35], v[12:15]
  s_waitcnt vmcnt(0)
  v_mfma_f32_16x16x32_bf16 v[12:15], v[100:103], v[36:39], v[12:15]
  s_mov_b32 s61, 0x40000
  s_nop 6
  ds_write_b128 v104, v[12:15]
  s_mov_b64 exec, 1
  ds_add_rtn_u32 v3, v114, v115 offset:16
  s_mov_b64 exec, -1
  ds_read_b64 v[40:41], v107 offset:0
  ds_read_b64 v[42:43], v107 offset:16
  ds_read_b64 v[44:45], v107 offset:32
  ds_read_b64 v[46:47], v107 offset:48
  ds_read_b128 v[24:27], v106 offset:0
  ds_read_b128 v[28:31], v106 offset:1024
  ds_read_b128 v[32:35], v106 offset:2048
  ds_read_b128 v[36:39], v106 offset:3072
  s_waitcnt lgkmcnt(4)
  v_readfirstlane_b32 s44, v3
  v_max3_f32 v20, v40, v42, v44
  v_max_f32 v20, v20, v46
  v_sub_f32 v40, v40, v20
  v_sub_f32 v42, v42, v20
  v_sub_f32 v44, v44, v20
  v_sub_f32 v46, v46, v20
  s_cmp_eq_u32 s44, 3
  s_cbranch_scc0 L_gather
  v_mul_f32 v40, s41, v40
  v_mul_f32 v42, s41, v42
  v_mul_f32 v44, s41, v44
  v_mul_f32 v46, s41, v46
  v_exp_f32 v40, v40
  v_exp_f32 v42, v42
  v_exp_f32 v44, v44
  v_exp_f32 v46, v46
  v_mul_f32 v22, v40, v41
  v_fmac_f32 v22, v42, v43
  v_fmac_f32 v22, v44, v45
  v_fmac_f32 v22, v46, v47
  s_waitcnt lgkmcnt(0)
  v_pk_mul_f32 v[24:25], v[24:25], v[40:41] op_sel_hi:[1,0]
  v_pk_mul_f32 v[26:27], v[26:27], v[40:41] op_sel_hi:[1,0]
  v_rcp_f32 v48, v22
  v_log_f32 v22, v22
  v_pk_fma_f32 v[24:25], v[28:29], v[42:43], v[24:25] op_sel_hi:[1,0,1]
  v_pk_fma_f32 v[26:27], v[30:31], v[42:43], v[26:27] op_sel_hi:[1,0,1]
  v_pk_fma_f32 v[24:25], v[32:33], v[44:45], v[24:25] op_sel_hi:[1,0,1]
  v_pk_fma_f32 v[26:27], v[34:35], v[44:45], v[26:27] op_sel_hi:[1,0,1]
  v_pk_fma_f32 v[24:25], v[36:37], v[46:47], v[24:25] op_sel_hi:[1,0,1]
  v_pk_fma_f32 v[26:27], v[38:39], v[46:47], v[26:27] op_sel_hi:[1,0,1]
  v_fmac_f32 v22, s41, v20
  v_pk_mul_f32 v[24:25], v[24:25], v[48:49] op_sel_hi:[1,0]
  v_pk_mul_f32 v[26:27], v[26:27], v[48:49] op_sel_hi:[1,0]
  v_cvt_pk_bf16_f32 v20, v24, v25
  v_cvt_pk_bf16_f32 v21, v26, v27
  s_cmp_eq_u32 s39, 2
  s_cbranch_scc0 L_pubfar
  buffer_store_dwordx4 v[20:23], v109, s[28:31], s55 offen
  s_branch L_pubdone
L_pubfar:
  buffer_store_dwordx4 v[20:23], v109, s[28:31], s55 offen sc1
L_pubdone:
  s_mov_b64 exec, 1
  ds_add_u32 v114, v115 offset:16
  s_mov_b64 exec, -1
L_gather:
  ds_read_b32 v24, v114 offset:16
  s_waitcnt lgkmcnt(0)
  v_readfirstlane_b32 s45, v24
  s_cmp_ge_u32 s45, 5
  s_cbranch_scc1 L_gather_ok
  s_sleep 1
  s_sub_u32 s61, s61, 1
  s_cbranch_scc0 L_gather
L_gather_ok:
  s_mov_b32 s61, 0x40000
L_ppoll:
  buffer_load_dwordx4 v[24:27], v108, s[28:31], s54 offen sc1
  s_cmp_lg_u32 s57, 0
  s_cbranch_scc1 L_havewo
  ds_read_b32 v3, v114 offset:12
  ds_read_b64_tr_b16 v[44:45], v112 offset:0
  ds_read_b64_tr_b16 v[46:47], v112 offset:1152
  ds_read_b64_tr_b16 v[48:49], v112 offset:8
  ds_read_b64_tr_b16 v[50:51], v112 offset:1160
  ds_read_b64_tr_b16 v[52:53], v112 offset:16
  ds_read_b64_tr_b16 v[54:55], v112 offset:1168
  ds_read_b64_tr_b16 v[56:57], v112 offset:9216
  ds_read_b64_tr_b16 v[58:59], v112 offset:10368
  ds_read_b64_tr_b16 v[60:61], v112 offset:9224
  ds_read_b64_tr_b16 v[62:63], v112 offset:10376
  ds_read_b64_tr_b16 v[64:65], v112 offset:9232
  ds_read_b64_tr_b16 v[66:67], v112 offset:10384
  s_waitcnt lgkmcnt(0)
  v_readfirstlane_b32 s57, v3
L_havewo:
  s_waitcnt vmcnt(0)
  v_cmp_eq_u32 vcc, s40, v27
  v_mov_b32 v28, v26
  v_mov_b32 v29, v26
  s_cmp_eq_u64 vcc, -1
  s_cbranch_scc1 L_pdone
  s_sub_u32 s61, s61, 1
  s_cbranch_scc0 L_ppoll
L_pdone:
  v_permlane32_swap_b32 v28, v29
  v_max_f32 v28, v28, v29
  v_mov_b32 v29, v28
  v_lshlrev_b32 v32, 16, v24
  v_and_b32 v33, 0xffff0000, v24
  v_permlane16_swap_b32 v28, v29
  v_max_f32 v28, v28, v29
  v_sub_f32 v28, v26, v28
  v_exp_f32 v28, v28
  v_lshlrev_b32 v34, 16, v25
  v_and_b32 v35, 0xffff0000, v25
  v_mov_b32 v29, v28
  v_pk_mul_f32 v[32:33], v[32:33], v[28:29] op_sel_hi:[1,0]
  v_pk_mul_f32 v[34:35], v[34:35], v[28:29] op_sel_hi:[1,0]
  v_permlane32_swap_b32 v28, v29
  v_permlane32_swap_b32 v32, v33
  v_permlane32_swap_b32 v34, v35
  v_add_f32 v28, v28, v29
  v_mov_b32 v29, v28
  v_add_f32 v32, v32, v33
  v_add_f32 v34, v34, v35
  v_permlane16_swap_b32 v28, v29
  v_add_f32 v28, v28, v29
  v_permlane16_swap_b32 v32, v34
  v_rcp_f32 v28, v28
  v_add_f32 v32, v32, v34
  v_mul_f32 v32, v32, v28
  v_cvt_pk_bf16_f32 v32, v32, v32
  ds_write_b16 v110, v32
  s_cmp_eq_u32 s3, 3
  s_waitcnt lgkmcnt(0)
  s_barrier
  s_cbranch_scc1 L_fin5
  ds_read_b128 v[36:39], v111
  ds_read_b128 v[40:43], v111 offset:64
  s_cmp_lg_u32 s57, 0
  s_cbranch_scc1 L_havewo2
  ds_read_b64_tr_b16 v[44:45], v112 offset:0
  ds_read_b64_tr_b16 v[46:47], v112 offset:1152
  ds_read_b64_tr_b16 v[48:49], v112 offset:8
  ds_read_b64_tr_b16 v[50:51], v112 offset:1160
  ds_read_b64_tr_b16 v[52:53], v112 offset:16
  ds_read_b64_tr_b16 v[54:55], v112 offset:1168
  ds_read_b64_tr_b16 v[56:57], v112 offset:9216
  ds_read_b64_tr_b16 v[58:59], v112 offset:10368
  ds_read_b64_tr_b16 v[60:61], v112 offset:9224
  ds_read_b64_tr_b16 v[62:63], v112 offset:10376
  ds_read_b64_tr_b16 v[64:65], v112 offset:9232
  ds_read_b64_tr_b16 v[66:67], v112 offset:10384
  s_waitcnt lgkmcnt(0)
L_havewo2:
  s_waitcnt lgkmcnt(1)
  v_mfma_f32_16x16x32_bf16 v[32:35], v[36:39], v[52:55], 0
  v_mfma_f32_16x16x32_bf16 v[28:31], v[36:39], v[48:51], 0
  v_mfma_f32_16x16x32_bf16 v[24:27], v[36:39], v[44:47], 0
  s_waitcnt lgkmcnt(0)
  v_mfma_f32_16x16x32_bf16 v[32:35], v[40:43], v[64:67], v[32:35]
  v_mfma_f32_16x16x32_bf16 v[28:31], v[40:43], v[60:63], v[28:31]
  v_mfma_f32_16x16x32_bf16 v[24:27], v[40:43], v[56:59], v[24:27]
  s_nop 5
  v_mov_b32 v22, v32
  v_mov_b32 v21, v28
  v_mov_b32 v20, v24
  buffer_store_dwordx4 v[20:23], v113, s[28:31], s58 offen sc1
  s_waitcnt vmcnt(0)
  s_barrier
L_fin5:
  s_endpgm
L_first:
  s_mov_b32 s57, 0
  s_waitcnt vmcnt(13)
  v_mfma_f32_16x16x32_bf16 v[24:27], v[104:107], v[4:7], 0
  v_mfma_f32_16x16x32_bf16 v[28:31], v[108:111], v[4:7], 0
  v_mfma_f32_16x16x32_bf16 v[32:35], v[112:115], v[4:7], 0
  v_mfma_f32_16x16x32_bf16 v[36:39], v[116:119], v[4:7], 0
  s_nop 4
  v_mov_b32_dpp v20, v24 quad_perm:[0,0,0,0] row_mask:0xf bank_mask:0xf
  v_mov_b32_dpp v21, v28 quad_perm:[0,0,0,0] row_mask:0xf bank_mask:0xf
  v_mov_b32_dpp v22, v32 quad_perm:[0,0,0,0] row_mask:0xf bank_mask:0xf
  v_mov_b32_dpp v23, v36 quad_perm:[0,0,0,0] row_mask:0xf bank_mask:0xf
  v_add_f32_dpp v20, v25, v20 quad_perm:[1,1,1,1] row_mask:0xf bank_mask:0xf
  v_add_f32_dpp v21, v29, v21 quad_perm:[1,1,1,1] row_mask:0xf bank_mask:0xf
  v_add_f32_dpp v22, v33, v22 quad_perm:[1,1,1,1] row_mask:0xf bank_mask:0xf
  v_add_f32_dpp v23, v37, v23 quad_perm:[1,1,1,1] row_mask:0xf bank_mask:0xf
  v_add_f32_dpp v20, v26, v20 quad_perm:[2,2,2,2] row_mask:0xf bank_mask:0xf
  v_add_f32_dpp v21, v30, v21 quad_perm:[2,2,2,2] row_mask:0xf bank_mask:0xf
  v_add_f32_dpp v22, v34, v22 quad_perm:[2,2,2,2] row_mask:0xf bank_mask:0xf
  v_add_f32_dpp v23, v38, v23 quad_perm:[2,2,2,2] row_mask:0xf bank_mask:0xf
  v_add_f32_dpp v20, v27, v20 quad_perm:[3,3,3,3] row_mask:0xf bank_mask:0xf
  v_add_f32_dpp v21, v31, v21 quad_perm:[3,3,3,3] row_mask:0xf bank_mask:0xf
  v_add_f32_dpp v22, v35, v22 quad_perm:[3,3,3,3] row_mask:0xf bank_mask:0xf
  v_add_f32_dpp v23, v39, v23 quad_perm:[3,3,3,3] row_mask:0xf bank_mask:0xf
  ds_write_b128 v2, v[20:23] offset:256
  v_max3_f32 v16, v16, v20, v21
  v_max3_f32 v16, v16, v22, v23
  v_mfma_f32_16x16x32_bf16 v[24:27], v[120:123], v[4:7], 0
  v_mfma_f32_16x16x32_bf16 v[28:31], v[124:127], v[4:7], 0
  v_mfma_f32_16x16x32_bf16 v[32:35], v[128:131], v[4:7], 0
  v_mfma_f32_16x16x32_bf16 v[36:39], v[132:135], v[4:7], 0
  s_nop 4
  v_mov_b32_dpp v20, v24 quad_perm:[0,0,0,0] row_mask:0xf bank_mask:0xf
  v_mov_b32_dpp v21, v28 quad_perm:[0,0,0,0] row_mask:0xf bank_mask:0xf
  v_mov_b32_dpp v22, v32 quad_perm:[0,0,0,0] row_mask:0xf bank_mask:0xf
  v_mov_b32_dpp v23, v36 quad_perm:[0,0,0,0] row_mask:0xf bank_mask:0xf
  v_add_f32_dpp v20, v25, v20 quad_perm:[1,1,1,1] row_mask:0xf bank_mask:0xf
  v_add_f32_dpp v21, v29, v21 quad_perm:[1,1,1,1] row_mask:0xf bank_mask:0xf
  v_add_f32_dpp v22, v33, v22 quad_perm:[1,1,1,1] row_mask:0xf bank_mask:0xf
  v_add_f32_dpp v23, v37, v23 quad_perm:[1,1,1,1] row_mask:0xf bank_mask:0xf
  v_add_f32_dpp v20, v26, v20 quad_perm:[2,2,2,2] row_mask:0xf bank_mask:0xf
  v_add_f32_dpp v21, v30, v21 quad_perm:[2,2,2,2] row_mask:0xf bank_mask:0xf
  v_add_f32_dpp v22, v34, v22 quad_perm:[2,2,2,2] row_mask:0xf bank_mask:0xf
  v_add_f32_dpp v23, v38, v23 quad_perm:[2,2,2,2] row_mask:0xf bank_mask:0xf
  v_add_f32_dpp v20, v27, v20 quad_perm:[3,3,3,3] row_mask:0xf bank_mask:0xf
  v_add_f32_dpp v21, v31, v21 quad_perm:[3,3,3,3] row_mask:0xf bank_mask:0xf
  v_add_f32_dpp v22, v35, v22 quad_perm:[3,3,3,3] row_mask:0xf bank_mask:0xf
  v_add_f32_dpp v23, v39, v23 quad_perm:[3,3,3,3] row_mask:0xf bank_mask:0xf
  ds_write_b128 v2, v[20:23] offset:384
  v_max3_f32 v16, v16, v20, v21
  v_max3_f32 v16, v16, v22, v23
  s_waitcnt vmcnt(4)
  buffer_load_dwordx4 v[60:63], v1, s[20:23], s49 offen offset:512 nt
  v_mfma_f32_16x16x32_bf16 v[24:27], v[136:139], v[4:7], 0
  v_mfma_f32_16x16x32_bf16 v[28:31], v[140:143], v[4:7], 0
  v_mfma_f32_16x16x32_bf16 v[32:35], v[144:147], v[4:7], 0
  v_mfma_f32_16x16x32_bf16 v[36:39], v[148:151], v[4:7], 0
  s_nop 4
  v_mov_b32_dpp v20, v24 quad_perm:[0,0,0,0] row_mask:0xf bank_mask:0xf
  v_mov_b32_dpp v21, v28 quad_perm:[0,0,0,0] row_mask:0xf bank_mask:0xf
  v_mov_b32_dpp v22, v32 quad_perm:[0,0,0,0] row_mask:0xf bank_mask:0xf
  v_mov_b32_dpp v23, v36 quad_perm:[0,0,0,0] row_mask:0xf bank_mask:0xf
  v_add_f32_dpp v20, v25, v20 quad_perm:[1,1,1,1] row_mask:0xf bank_mask:0xf
  v_add_f32_dpp v21, v29, v21 quad_perm:[1,1,1,1] row_mask:0xf bank_mask:0xf
  v_add_f32_dpp v22, v33, v22 quad_perm:[1,1,1,1] row_mask:0xf bank_mask:0xf
  v_add_f32_dpp v23, v37, v23 quad_perm:[1,1,1,1] row_mask:0xf bank_mask:0xf
  v_add_f32_dpp v20, v26, v20 quad_perm:[2,2,2,2] row_mask:0xf bank_mask:0xf
  v_add_f32_dpp v21, v30, v21 quad_perm:[2,2,2,2] row_mask:0xf bank_mask:0xf
  v_add_f32_dpp v22, v34, v22 quad_perm:[2,2,2,2] row_mask:0xf bank_mask:0xf
  v_add_f32_dpp v23, v38, v23 quad_perm:[2,2,2,2] row_mask:0xf bank_mask:0xf
  v_add_f32_dpp v20, v27, v20 quad_perm:[3,3,3,3] row_mask:0xf bank_mask:0xf
  v_add_f32_dpp v21, v31, v21 quad_perm:[3,3,3,3] row_mask:0xf bank_mask:0xf
  v_add_f32_dpp v22, v35, v22 quad_perm:[3,3,3,3] row_mask:0xf bank_mask:0xf
  v_add_f32_dpp v23, v39, v23 quad_perm:[3,3,3,3] row_mask:0xf bank_mask:0xf
  ds_write_b128 v2, v[20:23] offset:512
  v_max3_f32 v16, v16, v20, v21
  v_max3_f32 v16, v16, v22, v23
  v_mfma_f32_16x16x32_bf16 v[24:27], v[152:155], v[4:7], 0
  v_mfma_f32_16x16x32_bf16 v[28:31], v[156:159], v[4:7], 0
  v_mfma_f32_16x16x32_bf16 v[32:35], v[160:163], v[4:7], 0
  v_mfma_f32_16x16x32_bf16 v[36:39], v[164:167], v[4:7], 0
  s_nop 4
  v_mov_b32_dpp v20, v24 quad_perm:[0,0,0,0] row_mask:0xf bank_mask:0xf
  v_mov_b32_dpp v21, v28 quad_perm:[0,0,0,0] row_mask:0xf bank_mask:0xf
  v_mov_b32_dpp v22, v32 quad_perm:[0,0,0,0] row_mask:0xf bank_mask:0xf
  v_mov_b32_dpp v23, v36 quad_perm:[0,0,0,0] row_mask:0xf bank_mask:0xf
  v_add_f32_dpp v20, v25, v20 quad_perm:[1,1,1,1] row_mask:0xf bank_mask:0xf
  v_add_f32_dpp v21, v29, v21 quad_perm:[1,1,1,1] row_mask:0xf bank_mask:0xf
  v_add_f32_dpp v22, v33, v22 quad_perm:[1,1,1,1] row_mask:0xf bank_mask:0xf
  v_add_f32_dpp v23, v37, v23 quad_perm:[1,1,1,1] row_mask:0xf bank_mask:0xf
  v_add_f32_dpp v20, v26, v20 quad_perm:[2,2,2,2] row_mask:0xf bank_mask:0xf
  v_add_f32_dpp v21, v30, v21 quad_perm:[2,2,2,2] row_mask:0xf bank_mask:0xf
  v_add_f32_dpp v22, v34, v22 quad_perm:[2,2,2,2] row_mask:0xf bank_mask:0xf
  v_add_f32_dpp v23, v38, v23 quad_perm:[2,2,2,2] row_mask:0xf bank_mask:0xf
  v_add_f32_dpp v20, v27, v20 quad_perm:[3,3,3,3] row_mask:0xf bank_mask:0xf
  v_add_f32_dpp v21, v31, v21 quad_perm:[3,3,3,3] row_mask:0xf bank_mask:0xf
  v_add_f32_dpp v22, v35, v22 quad_perm:[3,3,3,3] row_mask:0xf bank_mask:0xf
  v_add_f32_dpp v23, v39, v23 quad_perm:[3,3,3,3] row_mask:0xf bank_mask:0xf
  ds_write_b128 v2, v[20:23] offset:640
  v_max3_f32 v16, v16, v20, v21
  v_max3_f32 v16, v16, v22, v23
  s_waitcnt vmcnt(4)
  buffer_load_dwordx4 v[64:67], v1, s[20:23], s49 offen offset:1024 nt
  v_add_u32 v2, 512, v2
  v_lshrrev_b32 v116, 4, v0
  v_lshlrev_b32 v117, 4, v0
  v_add_u32 v106, 19584, v117
  s_lshl_b32 s44, s3, 10
  v_add_u32 v104, s44, v106
  v_and_b32 v117, 8, v0
  v_add_u32 v107, 18976, v117
  s_lshl_b32 s44, s3, 4
  v_add_u32 v105, s44, v107
  v_lshlrev_b32 v109, 10, v117
  v_lshl_add_u32 v109, v116, 7, v109
  v_and_b32 v118, 7, v0
  v_lshl_add_u32 v109, v118, 4, v109
  s_lshl_b32 s44, s3, 7
  s_add_u32 s44, s44, 19072
  v_lshl_add_u32 v110, v117, 3, s44
  v_lshl_add_u32 v110, v118, 1, v110
  v_lshlrev_b32 v113, 14, v117
  v_lshl_add_u32 v113, v118, 4, v113
  v_lshrrev_b32 v118, 5, v0
  v_lshl_add_u32 v110, v118, 4, v110
  v_lshl_add_u32 v113, v118, 13, v113
  v_bfe_u32 v118, v0, 4, 1
  v_lshl_add_u32 v110, v118, 5, v110
  v_lshl_add_u32 v113, v118, 15, v113
  v_and_b32 v118, 15, v0
  v_lshlrev_b32 v108, 9, v116
  v_lshl_add_u32 v108, v118, 4, v108
  v_bfe_u32 v117, v0, 2, 2
  v_and_b32 v118, 3, v0
  v_lshl_add_u32 v112, v116, 3, v117
  v_mul_u32_u24 v112, 288, v112
  v_mad_u32_u24 v112, v118, 24, v112
  s_mul_i32 s44, s3, 96
  v_add_u32 v112, s44, v112
  v_lshlrev_b32 v111, 7, v117
  v_lshl_add_u32 v111, v116, 4, v111
  v_add_u32 v111, 19072, v111
  v_mov_b32 v114, 18944
  v_mov_b32 v115, 1
  s_bfe_u32 s44, s2, 0x10006
  s_mul_i32 s58, s44, 3
  s_add_u32 s58, s58, s3
  s_lshl_b32 s58, s58, 18
  s_lshr_b32 s44, s2, 7
  s_lshl_b32 s44, s44, 14
  s_add_u32 s58, s58, s44
  s_and_b32 s44, s2, 63
  s_lshl_b32 s44, s44, 7
  s_add_u32 s58, s58, s44
  s_add_u32 s58, s58, 65536
  s_and_b32 s55, s2, 0xf0
  s_lshl_b32 s55, s55, 13
  s_and_b32 s44, s2, 15
  s_lshl_b32 s44, s44, 9
  s_add_u32 s55, s55, s44
  s_add_u32 s55, s55, 32768
  s_and_b32 s54, s2, 48
  s_lshl_b32 s54, s54, 13
  s_and_b32 s44, s2, 12
  s_lshl_b32 s44, s44, 9
  s_add_u32 s54, s54, s44
  s_and_b32 s44, s2, 1
  s_lshl_b32 s44, s44, 8
  s_add_u32 s54, s54, s44
  s_and_b32 s44, s2, 2
  s_lshl_b32 s44, s44, 12
  s_add_u32 s54, s54, s44
  s_add_u32 s54, s54, 32768
  s_lshl_b32 s44, s3, 19
  s_add_u32 s54, s54, s44
  s_memrealtime s[62:63]
  s_waitcnt vmcnt(4)
  buffer_load_dwordx4 v[68:71], v1, s[20:23], s49 offen offset:1536 nt
  s_branch L_kk1
L_help:
  s_load_dword s60, s[18:19], 0
  s_mov_b64 s[28:29], s[18:19]
  s_mov_b32 s30, 33554432
  s_mov_b32 s31, 0x20000
  s_mov_b32 s61, 0x40000
  v_mul_u32_u24 v7, 1152, v8
  v_lshl_add_u32 v7, v9, 3, v7
  v_lshrrev_b32 v10, 2, v0
  v_lshlrev_b32 v10, 7, v10
  v_lshl_add_u32 v10, v8, 3, v10
  v_bfe_u32 v5, v0, 3, 2
  v_lshl_add_u32 v10, v5, 5, v10
  v_xor_b32 v11, 32, v10
  v_xor_b32 v12, 64, v10
  v_xor_b32 v13, 96, v10
  v_lshlrev_b32 v4, 12, v8
  v_lshl_add_u32 v4, v9, 4, v4
  v_bfe_u32 v5, v0, 2, 2
  v_lshl_add_u32 v4, v5, 6, v4
  s_lshr_b32 s53, s44, 2
  s_mul_i32 s53, s53, 0x24000
  s_add_u32 s53, s53, 4194304
  s_lshl_b32 s46, s47, 10
  s_add_u32 s45, s53, s46
  s_and_b32 s46, s44, 3
  s_lshl_b32 s46, s46, 8
  s_add_u32 s45, s45, s46
  s_mov_b32 s56, 0xf0f0f0f0
  s_mov_b32 s57, 0xf0f0f0f0
  s_mov_b32 s58, 0xff00ff00
  s_mov_b32 s59, 0xff00ff00
  s_mov_b32 s50, 0x07060501
  s_mov_b32 s51, 0x07060502
  s_mov_b32 s52, 0x07060503
  s_waitcnt lgkmcnt(0)
  s_mul_i32 s40, s60, 0x9e3779b1
  s_add_u32 s40, s40, 0x7f4a7c15
  s_getreg_b32 s42, hwreg(HW_REG_XCC_ID, 0, 4)
  s_lshl_b32 s43, s40, 4
  s_or_b32 s42, s42, s43
  v_mov_b32 v23, s42
  s_waitcnt vmcnt(18)
  ds_read_b64 v[40:41], v7 offset:19584
  ds_read_b64 v[42:43], v7 offset:19616
  ds_read_b64 v[44:45], v7 offset:19648
  ds_read_b64 v[46:47], v7 offset:19680
  ds_read_b64 v[48:49], v7 offset:19712
  ds_read_b64 v[50:51], v7 offset:19744
  ds_read_b64 v[52:53], v7 offset:19776
  ds_read_b64 v[54:55], v7 offset:19808
  ds_read_b64 v[56:57], v7 offset:19840
  s_waitcnt vmcnt(16)
  ds_read_b64_tr_b16 v[60:61], v10 offset:0
  ds_read_b64_tr_b16 v[62:63], v11 offset:0
  ds_read_b64_tr_b16 v[64:65], v12 offset:0
  ds_read_b64_tr_b16 v[66:67], v13 offset:0
  s_waitcnt vmcnt(14)
  s_waitcnt lgkmcnt(4)
  ds_read_b64_tr_b16 v[68:69], v10 offset:2048
  ds_read_b64_tr_b16 v[70:71], v11 offset:2048
  ds_read_b64_tr_b16 v[72:73], v12 offset:2048
  ds_read_b64_tr_b16 v[74:75], v13 offset:2048
  s_waitcnt lgkmcnt(4)
  v_mfma_f32_16x16x16_bf16 v[24:27], v[60:61], v[40:41], 0
  v_mfma_f32_16x16x16_bf16 v[28:31], v[62:63], v[40:41], 0
  v_mfma_f32_16x16x16_bf16 v[32:35], v[64:65], v[40:41], 0
  v_mfma_f32_16x16x16_bf16 v[36:39], v[66:67], v[40:41], 0
  s_waitcnt vmcnt(12)
  ds_read_b64_tr_b16 v[76:77], v10 offset:4096
  ds_read_b64_tr_b16 v[78:79], v11 offset:4096
  ds_read_b64_tr_b16 v[80:81], v12 offset:4096
  ds_read_b64_tr_b16 v[82:83], v13 offset:4096
  s_waitcnt lgkmcnt(4)
  v_mfma_f32_16x16x16_bf16 v[24:27], v[68:69], v[42:43], v[24:27]
  v_mfma_f32_16x16x16_bf16 v[28:31], v[70:71], v[42:43], v[28:31]
  v_mfma_f32_16x16x16_bf16 v[32:35], v[72:73], v[42:43], v[32:35]
  v_mfma_f32_16x16x16_bf16 v[36:39], v[74:75], v[42:43], v[36:39]
  s_waitcnt vmcnt(10)
  ds_read_b64_tr_b16 v[84:85], v10 offset:6144
  ds_read_b64_tr_b16 v[86:87], v11 offset:6144
  ds_read_b64_tr_b16 v[88:89], v12 offset:6144
  ds_read_b64_tr_b16 v[90:91], v13 offset:6144
  s_waitcnt lgkmcnt(4)
  v_mfma_f32_16x16x16_bf16 v[24:27], v[76:77], v[44:45], v[24:27]
  v_mfma_f32_16x16x16_bf16 v[28:31], v[78:79], v[44:45], v[28:31]
  v_mfma_f32_16x16x16_bf16 v[32:35], v[80:81], v[44:45], v[32:35]
  v_mfma_f32_16x16x16_bf16 v[36:39], v[82:83], v[44:45], v[36:39]
  s_waitcnt vmcnt(8)
  ds_read_b64_tr_b16 v[92:93], v10 offset:8192
  ds_read_b64_tr_b16 v[94:95], v11 offset:8192
  ds_read_b64_tr_b16 v[96:97], v12 offset:8192
  ds_read_b64_tr_b16 v[98:99], v13 offset:8192
  s_waitcnt lgkmcnt(4)
  v_mfma_f32_16x16x16_bf16 v[24:27], v[84:85], v[46:47], v[24:27]
  v_mfma_f32_16x16x16_bf16 v[28:31], v[86:87], v[46:47], v[28:31]
  v_mfma_f32_16x16x16_bf16 v[32:35], v[88:89], v[46:47], v[32:35]
  v_mfma_f32_16x16x16_bf16 v[36:39], v[90:91], v[46:47], v[36:39]
  s_waitcnt vmcnt(6)
  ds_read_b64_tr_b16 v[100:101], v10 offset:10240
  ds_read_b64_tr_b16 v[102:103], v11 offset:10240
  ds_read_b64_tr_b16 v[104:105], v12 offset:10240
  ds_read_b64_tr_b16 v[106:107], v13 offset:10240
  s_waitcnt lgkmcnt(4)
  v_mfma_f32_16x16x16_bf16 v[24:27], v[92:93], v[48:49], v[24:27]
  v_mfma_f32_16x16x16_bf16 v[28:31], v[94:95], v[48:49], v[28:31]
  v_mfma_f32_16x16x16_bf16 v[32:35], v[96:97], v[48:49], v[32:35]
  v_mfma_f32_16x16x16_bf16 v[36:39], v[98:99], v[48:49], v[36:39]
  s_waitcnt vmcnt(4)
  ds_read_b64_tr_b16 v[108:109], v10 offset:12288
  ds_read_b64_tr_b16 v[110:111], v11 offset:12288
  ds_read_b64_tr_b16 v[112:113], v12 offset:12288
  ds_read_b64_tr_b16 v[114:115], v13 offset:12288
  s_waitcnt lgkmcnt(4)
  v_mfma_f32_16x16x16_bf16 v[24:27], v[100:101], v[50:51], v[24:27]
  v_mfma_f32_16x16x16_bf16 v[28:31], v[102:103], v[50:51], v[28:31]
  v_mfma_f32_16x16x16_bf16 v[32:35], v[104:105], v[50:51], v[32:35]
  v_mfma_f32_16x16x16_bf16 v[36:39], v[106:107], v[50:51], v[36:39]
  s_waitcnt vmcnt(2)
  ds_read_b64_tr_b16 v[116:117], v10 offset:14336
  ds_read_b64_tr_b16 v[118:119], v11 offset:14336
  ds_read_b64_tr_b16 v[120:121], v12 offset:14336
  ds_read_b64_tr_b16 v[122:123], v13 offset:14336
  s_waitcnt lgkmcnt(4)
  v_mfma_f32_16x16x16_bf16 v[24:27], v[108:109], v[52:53], v[24:27]
  v_mfma_f32_16x16x16_bf16 v[28:31], v[110:111], v[52:53], v[28:31]
  v_mfma_f32_16x16x16_bf16 v[32:35], v[112:113], v[52:53], v[32:35]
  v_mfma_f32_16x16x16_bf16 v[36:39], v[114:115], v[52:53], v[36:39]
  s_waitcnt vmcnt(0)
  ds_read_b64_tr_b16 v[124:125], v10 offset:16384
  ds_read_b64_tr_b16 v[126:127], v11 offset:16384
  ds_read_b64_tr_b16 v[128:129], v12 offset:16384
  ds_read_b64_tr_b16 v[130:131], v13 offset:16384
  s_waitcnt lgkmcnt(4)
  v_mfma_f32_16x16x16_bf16 v[24:27], v[116:117], v[54:55], v[24:27]
  v_mfma_f32_16x16x16_bf16 v[28:31], v[118:119], v[54:55], v[28:31]
  v_mfma_f32_16x16x16_bf16 v[32:35], v[120:121], v[54:55], v[32:35]
  v_mfma_f32_16x16x16_bf16 v[36:39], v[122:123], v[54:55], v[36:39]
  s_waitcnt lgkmcnt(0)
  v_mfma_f32_16x16x16_bf16 v[24:27], v[124:125], v[56:57], v[24:27]
  v_mfma_f32_16x16x16_bf16 v[28:31], v[126:127], v[56:57], v[28:31]
  v_mfma_f32_16x16x16_bf16 v[32:35], v[128:129], v[56:57], v[32:35]
  v_mfma_f32_16x16x16_bf16 v[36:39], v[130:131], v[56:57], v[36:39]
  s_nop 5
  v_cndmask_b32 v24, v24, v28, s[56:57]
  v_cndmask_b32 v25, v25, v29, s[56:57]
  v_cndmask_b32 v26, v26, v30, s[56:57]
  v_cndmask_b32 v27, v27, v31, s[56:57]
  v_cndmask_b32 v32, v32, v36, s[56:57]
  v_cndmask_b32 v33, v33, v37, s[56:57]
  v_cndmask_b32 v34, v34, v38, s[56:57]
  v_cndmask_b32 v35, v35, v39, s[56:57]
  v_cndmask_b32 v24, v24, v32, s[58:59]
  v_cndmask_b32 v25, v25, v33, s[58:59]
  v_cndmask_b32 v26, v26, v34, s[58:59]
  v_cndmask_b32 v27, v27, v35, s[58:59]
  v_perm_b32 v20, v24, v27, s50
  v_perm_b32 v21, v25, v27, s51
  v_perm_b32 v22, v26, v27, s52
  buffer_store_dwordx4 v[20:23], v4, s[28:31], s45 offen sc1
  s_lshl_b32 s45, s47, 12
  s_add_u32 s45, s45, s53
  v_lshlrev_b32 v11, 3, v0
  v_add_u32 v11, 18432, v11
  s_mov_b32 s50, 0x0c04000c
  s_mov_b32 s51, 0x04020100
  s_mov_b32 s52, 0xffffff00
  s_waitcnt vmcnt(0)
  buffer_load_dwordx4 v[24:27], v2, s[28:31], s45 offen offset:0 sc1
  buffer_load_dwordx4 v[28:31], v2, s[28:31], s45 offen offset:1024 sc1
  buffer_load_dwordx4 v[32:35], v2, s[28:31], s45 offen offset:2048 sc1
  buffer_load_dwordx4 v[36:39], v2, s[28:31], s45 offen offset:3072 sc1
L_qpoll:
  s_waitcnt vmcnt(0)
  s_mov_b32 s44, 0
  v_and_b32 v5, -16, v27
  v_cmp_ne_u32 vcc, s43, v5
  s_cbranch_vccz L_qok0
  buffer_load_dwordx4 v[24:27], v2, s[28:31], s45 offen offset:0 sc1
  s_mov_b32 s44, 1
L_qok0:
  v_and_b32 v5, -16, v31
  v_cmp_ne_u32 vcc, s43, v5
  s_cbranch_vccz L_qok1
  buffer_load_dwordx4 v[28:31], v2, s[28:31], s45 offen offset:1024 sc1
  s_mov_b32 s44, 1
L_qok1:
  v_and_b32 v5, -16, v35
  v_cmp_ne_u32 vcc, s43, v5
  s_cbranch_vccz L_qok2
  buffer_load_dwordx4 v[32:35], v2, s[28:31], s45 offen offset:2048 sc1
  s_mov_b32 s44, 1
L_qok2:
  v_and_b32 v5, -16, v39
  v_cmp_ne_u32 vcc, s43, v5
  s_cbranch_vccz L_qok3
  buffer_load_dwordx4 v[36:39], v2, s[28:31], s45 offen offset:3072 sc1
  s_mov_b32 s44, 1
L_qok3:
  s_cmp_eq_u32 s44, 0
  s_cbranch_scc1 L_qdone
  s_sub_u32 s61, s61, 1
  s_cbranch_scc0 L_qpoll
  s_waitcnt vmcnt(0)
L_qdone:
  v_min3_u32 v5, v27, v31, v35
  v_max3_u32 v6, v27, v31, v35
  v_min_u32 v5, v5, v39
  v_max_u32 v6, v6, v39
  v_cmp_eq_u32 vcc, s42, v5
  v_cmp_eq_u32 s[62:63], s42, v6
  s_and_b64 vcc, vcc, s[62:63]
  s_cmp_eq_u64 vcc, -1
  s_cselect_b32 s44, 2, 1
  v_mov_b32 v23, s40
  v_perm_b32 v27, v25, v24, s50
  v_perm_b32 v27, v26, v27, s51
  v_and_b32 v24, s52, v24
  v_and_b32 v25, s52, v25
  v_and_b32 v26, s52, v26
  v_perm_b32 v31, v29, v28, s50
  v_perm_b32 v31, v30, v31, s51
  v_and_b32 v28, s52, v28
  v_and_b32 v29, s52, v29
  v_and_b32 v30, s52, v30
  v_perm_b32 v35, v33, v32, s50
  v_perm_b32 v35, v34, v35, s51
  v_and_b32 v32, s52, v32
  v_and_b32 v33, s52, v33
  v_and_b32 v34, s52, v34
  v_perm_b32 v39, v37, v36, s50
  v_perm_b32 v39, v38, v39, s51
  v_and_b32 v36, s52, v36
  v_and_b32 v37, s52, v37
  v_and_b32 v38, s52, v38
  v_add_f32 v24, v24, v28
  v_add_f32 v32, v32, v36
  v_add_f32 v25, v25, v29
  v_add_f32 v33, v33, v37
  v_add_f32 v26, v26, v30
  v_add_f32 v34, v34, v38
  v_add_f32 v27, v27, v31
  v_add_f32 v35, v35, v39
  v_add_f32 v24, v24, v32
  v_add_f32 v25, v25, v33
  v_add_f32 v26, v26, v34
  v_add_f32 v27, v27, v35
  v_cvt_pk_bf16_f32 v24, v24, v25
  v_cvt_pk_bf16_f32 v25, v26, v27
  v_mov_b32 v22, s44
  ds_write_b64 v11, v[24:25]
  ds_write_b64 v3, v[22:23]
  s_cmp_lg_u32 s2, 0
  s_cbranch_scc1 L_pwait
  s_movk_i32 s44, 12
  s_mov_b32 s45, -1
  s_mov_b32 s47, -1
  s_memtime s[48:49]
  s_waitcnt lgkmcnt(0)
L_probe:
  s_load_dword s46, s[18:19], 0x4000 glc
  s_waitcnt lgkmcnt(0)
  s_memtime s[50:51]
  s_waitcnt lgkmcnt(0)
  s_load_dword s46, s[18:19], 0x6000 glc
  s_waitcnt lgkmcnt(0)
  s_sub_u32 s52, s50, s48
  s_memtime s[48:49]
  s_waitcnt lgkmcnt(0)
  s_sub_u32 s53, s48, s50
  s_min_u32 s45, s45, s52
  s_min_u32 s47, s47, s53
  s_sub_u32 s44, s44, 1
  s_cmp_lg_u32 s44, 0
  s_cbranch_scc1 L_probe
  s_cmp_gt_u32 s45, s47
  s_cselect_b32 s45, 0x2001, 1
  v_mov_b32 v24, s45
  v_mov_b32 v25, v23
  s_mov_b64 exec, 1
  buffer_store_dwordx2 v[24:25], v2, s[28:31], 0 offen offset:256 sc1
  s_mov_b64 exec, -1
  v_lshrrev_b32 v4, 2, v0
  v_mul_u32_u24 v4, 0x24000, v4
  v_lshl_add_u32 v4, v8, 10, v4
  s_mov_b32 s45, 4194304
  s_mov_b32 s61, 0x40000
L_allq:
  buffer_load_dword v28, v4, s[28:31], s45 offen offset:12 sc1
  buffer_load_dword v29, v4, s[28:31], s45 offen offset:268 sc1
  buffer_load_dword v30, v4, s[28:31], s45 offen offset:524 sc1
  buffer_load_dword v31, v4, s[28:31], s45 offen offset:780 sc1
  s_waitcnt vmcnt(0)
  v_min3_u32 v32, v28, v29, v30
  v_max3_u32 v33, v28, v29, v30
  v_min_u32 v32, v32, v31
  v_max_u32 v33, v33, v31
  v_and_b32 v32, -16, v32
  v_and_b32 v33, -16, v33
  v_cmp_eq_u32 vcc, s43, v32
  v_cmp_eq_u32 s[62:63], s43, v33
  s_and_b64 vcc, vcc, s[62:63]
  s_cmp_eq_u64 vcc, -1
  s_cbranch_scc1 L_allq_ok
  s_sleep 16
  s_sub_u32 s61, s61, 1
  s_cbranch_scc0 L_allq
L_allq_ok:
  s_mov_b64 exec, 1
  buffer_store_dword v23, v2, s[28:31], 0 offen sc1
  s_mov_b64 exec, -1
L_pwait:
  s_mov_b32 s61, 0x100000
L_wait_mid:
  ds_read_b32 v24, v3 offset:24
  s_waitcnt lgkmcnt(0)
  v_readfirstlane_b32 s45, v24
  s_cmp_ge_u32 s45, 1
  s_cbranch_scc1 L_wait_mid_ok
  s_sleep 8
  s_sub_u32 s61, s61, 1
  s_cbranch_scc0 L_wait_mid
L_wait_mid_ok:
  s_mov_b32 s61, 0x40000
  v_mov_b32 v4, 0
L_ppw:
  buffer_load_dwordx2 v[24:25], v4, s[28:31], 0 offen offset:256 sc1
  s_waitcnt vmcnt(0)
  v_readfirstlane_b32 s45, v25
  v_readfirstlane_b32 s49, v24
  s_cmp_eq_u32 s45, s40
  s_cbranch_scc1 L_pgot
  s_sleep 16
  s_sub_u32 s61, s61, 1
  s_cbranch_scc0 L_ppw
L_pgot:
  s_and_b32 s49, s49, 0x2000
  s_mov_b64 s[32:33], s[12:13]
  s_and_b32 s48, s2, 63
  s_mul_i32 s48, s48, 73728
  s_lshr_b32 s45, s2, 6
  s_mul_i32 s45, s45, 288
  s_add_u32 s48, s48, s45
  v_mul_u32_u24 v4, 57, v0
  v_lshrrev_b32 v4, 10, v4
  v_mul_u32_u24 v4, 864, v4
  v_add_u32 v6, v4, v2
  s_lshr_b32 s55, s49, 11
  s_xor_b32 s55, s55, s24
  s_lshr_b32 s47, s55, 4
  s_lshl_b32 s47, s47, 17
  s_and_b32 s45, s55, 3
  s_lshl_b32 s45, s45, 14
  s_add_u32 s47, s47, s45
  s_and_b32 s45, s55, 4
  s_lshl_b32 s45, s45, 11
  s_add_u32 s47, s47, s45
  s_and_b32 s45, s55, 8
  s_lshl_b32 s46, s45, 9
  s_lshl_b32 s45, s45, 3
  s_add_u32 s47, s47, 65536
  s_add_u32 s46, s46, s47
  s_add_u32 s47, s47, s45
  v_lshrrev_b32 v1, 2, v0
  v_lshlrev_b32 v1, 7, v1
  v_lshl_add_u32 v1, v8, 4, v1
  v_add_u32 v7, 4096, v1
  s_mov_b64 s[36:37], s[14:15]
  s_and_b32 s56, s55, 7
  s_mul_i32 s56, s56, 24
  s_lshr_b32 s45, s55, 3
  s_add_u32 s56, s56, s45
  s_mul_i32 s56, s56, 24
  v_lshrrev_b32 v10, 5, v0
  v_bfe_u32 v11, v0, 4, 1
  v_lshl_add_u32 v10, v11, 1, v10
  v_lshlrev_b32 v10, 3, v10
  v_lshl_add_u32 v10, v8, 1, v10
  v_lshlrev_b32 v5, 7, v0
  s_mov_b32 m0, 0
  s_mov_b32 s61, 0x400000
L_wait_end:
  ds_read_b32 v24, v3 offset:8
  s_waitcnt lgkmcnt(0)
  v_readfirstlane_b32 s45, v24
  s_cmp_ge_u32 s45, 4
  s_cbranch_scc1 L_wait_end_ok
  s_sleep 2
  s_sub_u32 s61, s61, 1
  s_cbranch_scc0 L_wait_end
L_wait_end_ok:
  s_mov_b32 exec_hi, 0
  s_cmpk_ge_u32 s24, 192
  s_cbranch_scc1 L_notouch
  buffer_load_dword v49, v5, s[28:31], s46 offen sc1
L_notouch:
  s_mov_b32 exec_hi, 0x3fffff
L_wo:
  buffer_load_dwordx4 v6, s[32:35], s48 offen nt lds
  s_addk_i32 m0, 864
  s_addk_i32 s48, 3456
  s_cmpk_lt_u32 m0, 18144
  s_cbranch_scc1 L_wo
  s_mov_b64 exec, 0x3ffff
  buffer_load_dwordx4 v6, s[32:35], s48 offen nt lds
  s_mov_b64 exec, -1
  s_mov_b32 s61, 0x40000
  s_waitcnt vmcnt(0)
  ds_write_b32 v3, v22 offset:12
  s_cmpk_ge_u32 s24, 192
  s_barrier
  s_cbranch_scc1 L_fin
  s_barrier
  buffer_load_dwordx4 v[32:35], v1, s[28:31], s47 offen offset:0 sc1
  buffer_load_dwordx4 v[36:39], v1, s[28:31], s47 offen offset:2048 sc1
  buffer_load_dwordx4 v[40:43], v7, s[28:31], s47 offen offset:0 sc1
  buffer_load_dwordx4 v[44:47], v7, s[28:31], s47 offen offset:2048 sc1
L_ypoll:
  s_waitcnt vmcnt(0)
  s_mov_b32 s44, 0
  v_cmp_ne_u32 vcc, s40, v35
  s_cbranch_vccz L_yok0
  buffer_load_dwordx4 v[32:35], v1, s[28:31], s47 offen offset:0 sc1
  s_mov_b32 s44, 1
L_yok0:
  v_cmp_ne_u32 vcc, s40, v39
  s_cbranch_vccz L_yok1
  buffer_load_dwordx4 v[36:39], v1, s[28:31], s47 offen offset:2048 sc1
  s_mov_b32 s44, 1
L_yok1:
  v_cmp_ne_u32 vcc, s40, v43
  s_cbranch_vccz L_yok2
  buffer_load_dwordx4 v[40:43], v7, s[28:31], s47 offen offset:0 sc1
  s_mov_b32 s44, 1
L_yok2:
  v_cmp_ne_u32 vcc, s40, v47
  s_cbranch_vccz L_yok3
  buffer_load_dwordx4 v[44:47], v7, s[28:31], s47 offen offset:2048 sc1
  s_mov_b32 s44, 1
L_yok3:
  s_cmp_eq_u32 s44, 0
  s_cbranch_scc1 L_ydone
  s_sub_u32 s61, s61, 1
  s_cbranch_scc0 L_ypoll
  s_waitcnt vmcnt(0)
L_ydone:
  v_pk_add_f32 v[32:33], v[32:33], v[36:37]
  v_pk_add_f32 v[40:41], v[40:41], v[44:45]
  v_add_f32 v34, v34, v38
  v_add_f32 v42, v42, v46
  v_pk_add_f32 v[32:33], v[32:33], v[40:41]
  v_add_f32 v34, v34, v42
  v_mov_b32 v35, v34
  v_permlane32_swap_b32 v32, v33
  v_add_f32 v32, v32, v33
  v_permlane32_swap_b32 v34, v35
  v_add_f32 v34, v34, v35
  s_nop 1
  v_permlane16_swap_b32 v32, v34
  v_add_f32 v32, v32, v34
  s_nop 1
  v_add_f32_dpp v32, v32, v32 row_ror:8 row_mask:0xf bank_mask:0xf
  s_nop 1
  v_add_f32_dpp v32, v32, v32 row_ror:4 row_mask:0xf bank_mask:0xf
  s_mov_b32 exec_lo, 0x000f000f
  s_mov_b32 exec_hi, 0x0000000f
  v_cvt_pk_bf16_f32 v32, v32, v32
  buffer_store_short v32, v10, s[36:39], s56 offen
L_fin:
L_end:
  s_endpgm
.section .rodata,"a"
.p2align 6
.amdhsa_kernel standalone__gqa_block_cached__decode_kernel
  .amdhsa_next_free_vgpr 168
  .amdhsa_next_free_sgpr 64
  .amdhsa_accum_offset 168
  .amdhsa_group_segment_fixed_size 0
  .amdhsa_kernarg_size 64
  .amdhsa_user_sgpr_count 2
  .amdhsa_user_sgpr_kernarg_segment_ptr 1
  .amdhsa_system_sgpr_workgroup_id_x 1
  .amdhsa_float_denorm_mode_32 3
.end_amdhsa_kernel
```
